```python
import torch

def _softmax(x, axis=-1):
    return torch.softmax(x, dim=axis)
def _gelu(x):
    return torch.nn.functional.gelu(x, approximate="tanh")
def _silu(x):
    return torch.nn.functional.silu(x)
def _sigmoid(x):
    return torch.sigmoid(x)
def _layernorm(x, axis=-1, eps=1e-5):
    m = x.mean(dim=axis, keepdim=True)
    v = x.var(dim=axis, keepdim=True, unbiased=False)
    return (x - m) / torch.sqrt(v + eps)
def _scatter_add(tgt, idx, src, axis=0):
    return tgt.clone().index_add_(axis, idx, src)
def _segment_sum(src, seg, n):
    out = torch.zeros((n,) + src.shape[1:], dtype=src.dtype)
    return out.index_add_(0, seg, src)
def _pad(x, pw):
    flat = tuple(v for pair in reversed(pw) for v in pair)
    return torch.nn.functional.pad(x, flat)

kernel_name = 'gated_mix__mha_block__moe_arch_mod__prompt'

def setup_inputs():

    _w = (lambda a: (lambda t: t.to(torch.bfloat16) if t.is_floating_point() else t)(torch.as_tensor(a)))
    def _A_setup():
        B, S, D, H = 1, 2048, 576, 32
        return {
            "x": _w((lambda *s: torch.randn(*s, dtype=torch.bfloat16) * 0.05)(B, S, D)),
            "wqkv": _w((lambda *s: torch.randn(*s, dtype=torch.bfloat16) * 0.8)(D, 3 * D)),
            "wo": _w((lambda *s: torch.randn(*s, dtype=torch.bfloat16) * 0.1)(D, D)),
        }
    _A_in = _A_setup()

    def _B_setup():
        B, S, D, F, C = 1, 2048, 576, 4608, 2
        return {
            "x": _w((lambda *s: torch.randn(*s, dtype=torch.bfloat16) * 0.05)(B, S, D)),
            "w_r": _w((lambda *s: torch.randn(*s, dtype=torch.bfloat16) * 3.2)(D)),
            "w_gate": _w((lambda *s: torch.randn(*s, dtype=torch.bfloat16) * 0.2)(D, F)),
            "w_up": _w((lambda *s: torch.randn(*s, dtype=torch.bfloat16) * 0.2)(D, F)),
            "w_down": _w((lambda *s: torch.randn(*s, dtype=torch.bfloat16) * 0.2)(F, D)),
        }
    _B_in = _B_setup()

    return {
        "A_x": _A_in["x"],
        "A_wqkv": _A_in["wqkv"],
        "A_wo": _A_in["wo"],
        "B_x": _B_in["x"],
        "B_w_r": _B_in["w_r"],
        "B_w_gate": _B_in["w_gate"],
        "B_w_up": _B_in["w_up"],
        "B_w_down": _B_in["w_down"],
        "gate_w": _w((lambda *s: torch.randn(*s, dtype=torch.bfloat16) * 0.05)(576) * 16.0),
    }

def reference(A_x, A_wqkv, A_wo, B_x, B_w_r, B_w_gate, B_w_up, B_w_down, gate_w):
    def _A_ref(x, wqkv, wo):
        B, S, D = x.shape
        H = 32
        Dh = D // H
        qkv = (lambda x, *d: x.permute(*d))((x @ wqkv).reshape(B, S, 3, H, Dh), 2, 0, 3, 1, 4)
        q, k, v = qkv[0], qkv[1], qkv[2]
        scores = torch.einsum("bhqd,bhkd->bhqk", q, k) * (Dh ** -0.5)
        p = _softmax(scores, axis=-1)
        o = torch.einsum("bhqk,bhkd->bhqd", p, v)
        return (lambda x, *d: x.permute(*d))(o, 0, 2, 1, 3).reshape(B, S, D) @ wo

    def _B_ref(x, w_r, w_gate, w_up, w_down):
        B, S, D = x.shape
        C = 2
        r = x @ w_r
        idx = torch.argsort(-r, axis=-1)[:, :C]
        idx_e = (lambda x, n, axis: torch.repeat_interleave(x, n, dim=axis))(idx.reshape(B, C, 1), D, axis=2)
        x_sel = (lambda x, i, axis: torch.take_along_dim(x, i, dim=axis))(x, idx_e, axis=1)
        g = _silu(x_sel @ w_gate)
        u = x_sel @ w_up
        y = (g * u) @ w_down
        r_sel = _sigmoid((lambda x, i, axis: torch.take_along_dim(x, i, dim=axis))(r, idx, axis=1))
        y = y * r_sel.reshape(B, C, 1)
        b_off = (torch.arange(B) * S).reshape(B, 1)
        flat_idx = (idx + b_off).reshape(B * C)
        zero = (x * 0.0).reshape(B * S, D)
        upd = _scatter_add(zero, flat_idx, y.reshape(B * C, D), axis=0)
        return x + upd.reshape(B, S, D)

    x = A_x
    g = _sigmoid((x * gate_w).sum(-1, keepdims=True))
    a = _A_ref(x, A_wqkv, A_wo)
    b = _B_ref(x, B_w_r, B_w_gate, B_w_up, B_w_down)
    return g * a + (1 - g) * b
```

```asm
; @launch grid=(256,1,1) block=(768,1,1) lds=163840
.amdgcn_target "amdgcn-amd-amdhsa--gfx950"
.text
.globl gated_mix__mha_block__moe_arch_mod__prompt_kernel
.p2align 8
.type gated_mix__mha_block__moe_arch_mod__prompt_kernel,@function
gated_mix__mha_block__moe_arch_mod__prompt_kernel:
    s_load_dwordx2 s[8:9], s[0:1], 0
    s_load_dwordx2 s[12:13], s[0:1], 8
    s_load_dwordx16 s[32:47], s[0:1], 0
    s_load_dwordx2 s[16:17], s[0:1], 88
    s_load_dwordx2 s[20:21], s[0:1], 80
    s_load_dwordx4 s[48:51], s[0:1], 64
    v_lshrrev_b32 v2, 6, v0
    v_and_b32 v1, 63, v0
    s_cmp_ge_u32 s2, 256
    s_cbranch_scc1 L_end
    v_readfirstlane_b32 s3, v2
    s_and_b32 s4, s2, 7
    s_lshr_b32 s5, s2, 3
    s_mov_b32 s10, 2359296
    s_mov_b32 s11, 0x00020000
    s_mov_b32 s14, 1990656
    s_mov_b32 s15, s11
    s_mov_b32 s18, 19505152
    s_mov_b32 s19, s11
    s_movk_i32 s22, 256
    s_mov_b32 s23, s11
    s_cmp_eq_u32 s5, 24
    s_cbranch_scc1 L_clear
L_cleared:
    s_cmp_lt_u32 s3, 8
    s_cbranch_scc1 L_loader
    s_cmp_lt_u32 s5, 28
    s_cbranch_scc1 L_service
    v_and_b32 v3, 0xff, v0
    s_getpc_b64 s[24:25]
L_pc1:
    s_sub_u32 s24, s24, L_pc1 - gated_mix__mha_block__moe_arch_mod__prompt_kernel
    s_subb_u32 s25, s25, 0
    v_min_u32 v3, (L_codeend - gated_mix__mha_block__moe_arch_mod__prompt_kernel - 4) / 128, v3
    v_lshlrev_b32 v3, 7, v3
    global_load_dword v165, v3, s[24:25]
    s_branch L_service
L_loader:
    s_cmp_ge_u32 s5, 24
    s_cbranch_scc1 L_ld_none
    s_setprio 3
    s_lshr_b32 s28, s5, 3
    s_mul_i32 s29, s28, 3
    s_add_u32 s29, s29, s5
    s_add_u32 s29, s29, s3
    s_and_b32 s29, s29, 7
    s_and_b32 s26, s5, 7
    s_and_b32 s27, s4, 1
    s_lshl3_add_u32 s26, s27, s26
    s_lshl3_add_u32 s26, s26, s29
    s_mul_i32 s26, s26, 18432
    s_lshl_b32 s27, s29, 2
    v_lshrrev_b32 v3, 3, v1
    v_mul_u32_u24 v3, 1152, v3
    v_bfe_u32 v12, v1, 4, 1
    v_bitop3_b32 v12, v12, v1, s27 bitop3:0x96
    v_and_b32 v12, 7, v12
    v_lshlrev_b32 v12, 4, v12
    v_add3_u32 v130, v12, v3, s26
    s_movk_i32 s27, 8192
    v_xad_u32 v131, v130, 32, s27
    s_mul_i32 s26, s29, 96
    s_lshl2_add_u32 s26, s28, s26
    s_lshr_b32 s27, s4, 1
    s_add_u32 s26, s26, s27
    s_mul_i32 s26, s26, 288
    v_mul_u32_u24 v3, 57, v1
    v_lshrrev_b32 v3, 10, v3
    v_mul_u32_u24 v3, 3168, v3
    v_lshlrev_b32 v12, 4, v1
    v_add3_u32 v132, v12, v3, s26
    s_movk_i32 s27, 9504
    v_add_u32 v133, s27, v132
    v_add_u32 v134, s27, v133
    s_lshl_b32 s59, s29, 11
    s_mul_i32 s61, s29, 384
    s_addk_i32 s61, 16384
    s_mov_b32 s56, s4
    s_mov_b32 s60, 0
    s_waitcnt lgkmcnt(0)
L_ldloop:
    s_mov_b32 m0, s59
    s_lshl_b32 s57, s56, 7
    buffer_load_dwordx4 v130, s[8:11], s57 offen lds
    buffer_load_dwordx4 v131, s[8:11], s57 offen offset:1024 lds
    s_add_u32 m0, s59, s61
    s_mul_i32 s57, s56, 221184
    s_mov_b32 exec_hi, 0x3fffff
    buffer_load_dwordx4 v132, s[12:15], s57 offen lds
    buffer_load_dwordx4 v133, s[12:15], s57 offen offset:864 lds
    s_mov_b32 exec_hi, 15
    buffer_load_dwordx4 v134, s[12:15], s57 offen offset:1728 lds
    s_mov_b32 exec_hi, -1
    s_setprio 1
    s_add_u32 s59, s59, 35840
    s_cmp_ge_u32 s59, 143360
    s_cselect_b32 s58, 143360, 0
    s_sub_u32 s59, s59, s58
    s_add_u32 s56, s56, 1
    s_cmp_eq_u32 s56, 9
    s_cselect_b32 s56, 0, s56
    s_add_u32 s60, s60, 1
    s_cmp_eq_u32 s60, 1
    s_cbranch_scc1 L_ldloop
    s_cmp_eq_u32 s60, 9
    s_cbranch_scc1 L_ld_done
    s_waitcnt vmcnt(5)
    s_barrier
    s_branch L_ldloop
L_clear:
    s_mul_i32 s24, s4, 12288
    s_add_u32 s24, s24, 19398656
    v_lshlrev_b32 v3, 4, v0
    v_mov_b64 v[4:5], 0
    v_mov_b64 v[6:7], 0
    v_mov_b32 v8, 1
    s_waitcnt lgkmcnt(0)
    buffer_store_dwordx4 v[4:7], v3, s[16:19], s24 offen sc1
    s_lshl_b32 s24, s4, 5
    s_cmp_lg_u32 s3, 0
    s_waitcnt vmcnt(0)
    s_barrier
    s_cbranch_scc1 L_cleared
    s_mov_b64 exec, 1
    buffer_store_dword v8, v4, s[20:23], s24 offen sc1
    s_mov_b64 exec, -1
    s_branch L_cleared
L_clear1:
    s_setprio 3
    s_mul_i32 s24, s4, 12288
    s_add_u32 s24, s24, 19398656
    v_lshlrev_b32 v3, 4, v1
    v_mov_b64 v[4:5], 0
    v_mov_b64 v[6:7], 0
    v_mov_b32 v8, 1
    s_add_u32 s25, s24, 12288
    s_waitcnt lgkmcnt(0)
L_clear2:
    buffer_store_dwordx4 v[4:7], v3, s[16:19], s24 offen sc1
    buffer_store_dwordx4 v[4:7], v3, s[16:19], s24 offen offset:1024 sc1
    buffer_store_dwordx4 v[4:7], v3, s[16:19], s24 offen offset:2048 sc1
    buffer_store_dwordx4 v[4:7], v3, s[16:19], s24 offen offset:3072 sc1
    s_add_u32 s24, s24, 4096
    s_cmp_lt_u32 s24, s25
    s_cbranch_scc1 L_clear2
    s_lshl_b32 s24, s4, 5
    s_mov_b64 exec, 1
    s_waitcnt vmcnt(0)
    buffer_store_dword v8, v4, s[20:23], s24 offen sc1
    s_mov_b64 exec, -1
    s_branch L_service
L_ld_none:
    s_and_b32 s26, s5, 7
    s_add_u32 s56, s4, s3
    s_add_u32 s56, s56, 2
    s_mul_i32 s27, s56, 57
    s_lshr_b32 s27, s27, 9
    s_mul_i32 s27, s27, 9
    s_sub_u32 s56, s56, s27
    s_lshl3_add_u32 s58, s56, s26
    s_mul_i32 s58, s58, 27648
    s_lshr_b32 s27, s4, 1
    s_lshl_b32 s27, s27, 8
    s_add_u32 s58, s58, s27
    s_lshl_b32 s56, s56, 7
    s_and_b32 s27, s4, 1
    s_lshl3_add_u32 s26, s27, s26
    s_mul_i32 s26, s26, 147456
    s_add_u32 s56, s56, s26
    s_add_u32 s57, s56, 73728
    v_mul_u32_u24 v3, 1152, v1
    v_min_u32 v4, 35, v1
    v_mul_u32_u24 v5, 21846, v4
    v_lshrrev_b32 v5, 16, v5
    v_mul_u32_u24 v5, 6, v5
    v_add_lshl_u32 v4, v4, v5, 7
    s_add_u32 s59, s58, 13824
    s_cmp_gt_u32 s3, 6
    s_waitcnt lgkmcnt(0)
    s_cbranch_scc1 L_ld_done
    buffer_load_dword v130, v3, s[8:11], s56 offen
    buffer_load_dword v130, v3, s[8:11], s57 offen
    buffer_load_dword v130, v4, s[12:15], s58 offen
    buffer_load_dword v130, v4, s[12:15], s59 offen
L_ld_done:
    s_setprio 0
    s_getreg_b32 s24, hwreg(HW_REG_XCC_ID)
    s_and_b32 s24, s24, 15
    s_add_u32 s7, s24, 1
    s_and_b32 s24, s4, 1
    s_lshr_b32 s25, s4, 1
    s_lshl2_add_u32 s6, s24, s25
    s_lshr_b32 s38, s5, 3
    s_lshl2_add_u32 s38, s24, s38
    s_and_b32 s39, s5, 7
    s_lshl3_add_u32 s39, s25, s39
    s_mul_i32 s15, s38, 884736
    s_mul_i32 s24, s39, 27648
    s_add_u32 s15, s15, s24
    s_add_u32 s15, s15, 7340032
    s_mul_i32 s24, s3, 3456
    s_add_u32 s24, s24, s15
    v_min_u32 v111, 26, v1
    v_lshlrev_b32 v111, 7, v111
    buffer_load_dword v111, v111, s[16:19], s24 offen sc1
    s_cmp_ge_u32 s5, 24
    s_cbranch_scc1 L_nb2
    s_waitcnt vmcnt(6)
    s_barrier
L_nb2:
    v_and_b32 v118, 7, v1
    v_lshlrev_b32 v118, 5, v118
    s_cmp_ge_u32 s5, 24
    s_cbranch_scc1 L_nb3
    s_waitcnt vmcnt(1)
    s_barrier
L_nb3:
    buffer_load_dword v119, v118, s[20:23], 0 offen sc1
    s_barrier
    v_lshrrev_b32 v105, 3, v1
    v_mul_u32_u24 v105, 1152, v105
    v_and_b32 v106, 7, v1
    v_lshl_add_u32 v129, v106, 2, v105
    v_mov_b32 v128, 0x3f803f80
    v_mov_b32 v10, 156672
    v_mul_u32_u24 v105, 7282, v0
    v_lshrrev_b32 v105, 16, v105
    v_mul_u32_u24 v106, 9, v105
    v_sub_u32 v106, v0, v106
    s_and_b32 s24, s5, 3
    s_lshl2_add_u32 s24, s6, s24
    s_lshl_b32 s24, s24, 6
    s_lshr_b32 s25, s5, 2
    s_mul_i32 s25, s25, 144
    v_lshl_add_u32 v153, v105, 2, v10
    v_add_u32 v105, s24, v105
    v_sub_u32 v154, 2047, v105
    v_mul_u32_u24 v7, 1152, v105
    v_lshl_add_u32 v7, v106, 4, v7
    v_add_u32 v7, s25, v7
    v_lshlrev_b32 v152, 5, v0
    v_add_u32 v152, 119808, v152
    v_mov_b64 v[40:41], 0
    v_mov_b64 v[42:43], 0
    v_mov_b64 v[44:45], 0
    v_mov_b64 v[46:47], 0
    v_mov_b64 v[48:49], 0
    v_mov_b64 v[50:51], 0
    v_mov_b64 v[52:53], 0
    v_mov_b64 v[54:55], 0
    v_mov_b64 v[56:57], 0
    v_mov_b64 v[58:59], 0
    v_mov_b64 v[60:61], 0
    v_mov_b64 v[62:63], 0
    v_mov_b64 v[64:65], 0
    v_mov_b64 v[66:67], 0
    v_mov_b64 v[68:69], 0
    v_mov_b64 v[70:71], 0
    ds_write_b32 v129, v128
    s_lshr_b32 s12, s3, 2
    s_and_b32 s13, s3, 3
    s_mul_i32 s24, s12, 9216
    s_add_u32 s24, s24, 9216
    v_lshrrev_b32 v120, 5, v1
    v_bfe_u32 v121, v1, 2, 2
    v_and_b32 v122, 3, v1
    v_lshlrev_b32 v122, 3, v122
    v_bfe_u32 v123, v1, 4, 1
    v_lshrrev_b32 v124, 4, v1
    v_lshl_add_u32 v108, v120, 3, v121
    v_lshl_or_b32 v108, v108, 5, v122
    v_mul_u32_u24 v109, 1152, v123
    v_add3_u32 v2, v109, v108, s24
    v_and_b32 v105, 1, v121
    v_lshl_or_b32 v105, v105, 5, v122
    v_add_u32 v105, 512, v105
    v_mul_u32_u24 v109, 1152, v124
    v_add3_u32 v3, v109, v105, s24
    s_mul_i32 s25, s13, 2304
    s_add_u32 s25, s25, 138240
    v_mul_u32_u24 v109, 576, v124
    v_add3_u32 v114, v109, v105, s25
    v_mul_u32_u24 v109, 576, v123
    v_add3_u32 v112, v109, v108, s25
    v_and_b32 v105, 31, v1
    v_lshlrev_b32 v106, 4, v120
    v_lshl_or_b32 v107, v105, 5, v106
    v_xor_b32 v106, 16, v106
    v_cmp_gt_u32 vcc, 16, v105
    v_lshl_add_u32 v108, v105, 3, v106
    v_add_u32 v108, 384, v108
    s_add_u32 s24, s24, 576
    v_cndmask_b32 v107, v108, v107, vcc
    v_add_u32 v107, s24, v107
    s_mov_b32 vcc_lo, 0x0011ffff
    s_mov_b32 vcc_hi, 0x0011ffff
    v_mov_b32 v108, 18432
    v_mov_b32 v6, 0xdddddddd
    v_cndmask_b32 v4, v106, v107, vcc
    v_cndmask_b32 v5, 0, v108, vcc
    s_mov_b32 vcc_lo, 0x0033ffff
    s_mov_b32 vcc_hi, 0x0033ffff
    v_mov_b32 v108, 167936
    s_nop 0
    v_cndmask_b32 v4, v108, v4, vcc
    v_lshlrev_b32 v145, 2, v105
    v_lshlrev_b32 v144, 4, v1
    v_lshrrev_b32 v126, 3, v1
    v_min_u32 v126, 2, v126
    v_and_b32 v105, 7, v1
    v_lshl_or_b32 v126, v126, 5, v105
    s_and_b32 s24, s5, 24
    v_add_u32 v126, s24, v126
    s_lshl_b32 s24, s4, 9
    s_add_u32 s24, s24, 19431424
    v_lshl_add_u32 v115, v126, 2, s24
    v_mov_b32 v11, 1
    v_mov_b32 v155, 0
    s_lshl_b32 s24, s3, 2
    s_add_u32 s24, s24, 156736
    v_min_u32 v156, 1, v1
    v_lshl_add_u32 v156, v156, 13, s24
    v_min_u32 v157, 8, v1
    v_lshl_add_u32 v157, v157, 2, v10
    s_mul_i32 s24, s13, 2560
    s_add_u32 s24, s24, 101376
    v_add_u32 v140, s24, v144
    v_lshl_add_u32 v141, v1, 3, s24
    s_add_u32 s25, s24, 10240
    s_cmp_eq_u32 s13, 3
    s_cselect_b32 s25, 160256, s25
    v_add_u32 v142, s25, v144
    v_lshl_add_u32 v143, v1, 3, s25
    s_bfe_u32 s28, s3, 0x10001
    s_and_b32 s29, s3, 1
    s_lshl1_add_u32 s29, s12, s29
    v_mul_u32_u24 v105, 18, v120
    v_lshl_add_u32 v105, v123, 2, v105
    v_add_u32 v105, v105, v121
    v_mul_u32_u24 v105, 160, v105
    s_mul_i32 s24, s28, 46080
    s_add_u32 s24, s24, 9216
    v_add3_u32 v146, v105, v122, s24
    v_lshrrev_b32 v105, 1, v121
    v_lshl_add_u32 v105, v124, 2, v105
    v_mul_u32_u24 v105, 18, v105
    v_and_b32 v106, 1, v121
    v_add3_u32 v105, v105, v106, 16
    v_mul_u32_u24 v105, 160, v105
    v_add3_u32 v147, v105, v122, s24
    v_and_b32 v105, 15, v1
    s_and_b32 s24, s29, 1
    s_lshl_b32 s24, s24, 4
    v_add_u32 v106, s24, v105
    v_lshlrev_b32 v107, 9, v124
    v_lshl_add_u32 v150, v106, 2, v107
    v_lshl_add_u32 v149, v106, 4, v107
    s_lshl_b32 s24, s29, 4
    v_add_u32 v105, s24, v105
    v_mul_u32_u24 v105, 288, v105
    s_mul_i32 s24, s28, 18432
    s_add_u32 s24, s24, 119808
    v_lshlrev_b32 v106, 4, v124
    v_add3_u32 v151, v105, v106, s24
    s_lshl2_add_u32 s24, s38, s13
    s_lshl_b32 s24, s24, 6
    s_add_u32 s24, s24, s39
    s_lshl_b32 s52, s24, 10
    s_add_u32 s52, s52, 14680064
    s_lshl_b32 s53, s24, 7
    s_add_u32 s53, s53, 16777216
    s_and_b32 s24, s5, 3
    s_lshl2_add_u32 s24, s6, s24
    s_lshr_b32 s25, s29, 1
    s_lshl1_add_u32 s24, s24, s25
    s_lshl1_add_u32 s24, s24, s28
    s_lshl_b32 s24, s24, 4
    s_lshl_b32 s55, s24, 10
    s_add_u32 s55, s55, 14680064
    s_lshl_b32 s56, s24, 7
    s_add_u32 s56, s56, 16777216
    s_add_u32 s57, s55, 4096
    s_add_u32 s58, s55, 8192
    s_add_u32 s59, s55, 12288
    s_lshl_b32 s24, s13, 2
    s_add_u32 s24, s24, 156800
    v_mov_b32 v148, s24
    v_lshlrev_b32 v117, 4, v0
    s_lshl_b32 s25, s3, 10
    s_add_u32 s26, s25, 136192
    s_add_u32 s25, s25, 9216
    s_add_u32 s27, s25, 16384
    s_cmp_lt_u32 s3, 2
    s_cselect_b32 s27, s27, s26
    s_mov_b32 s14, 0
    s_mov_b32 s61, 0
    s_cmp_lg_u32 s3, 0
    s_cbranch_scc1 L_follow
    s_movk_i32 s30, 16384
    s_branch L_chk6
L_poll4:
    buffer_load_dword v119, v118, s[20:23], 0 offen sc1
L_chk6:
    s_waitcnt vmcnt(0)
    v_cmp_eq_u32 vcc, 0, v119
    s_cbranch_vccz L_ok5
    s_sleep 32
    s_sub_u32 s30, s30, 1
    s_cmp_lg_u32 s30, 0
    s_cbranch_scc1 L_poll4
L_ok5:
    s_mov_b32 exec_hi, 0
    s_movk_i32 s30, 16384
L_poll7:
    buffer_load_dword v106, v115, s[16:19], 0 offen sc1
    ds_read_b32 v107, v10 offset:12
    s_waitcnt vmcnt(0)
    v_cmp_ne_u32 vcc, s7, v106
    s_cbranch_vccz L_ok8
    s_waitcnt lgkmcnt(0)
    v_cmp_eq_u32 vcc, 2, v107
    s_cbranch_vccnz L_general1
    s_sub_u32 s30, s30, 1
    s_cmp_lg_u32 s30, 0
    s_cbranch_scc1 L_poll7
L_ok8:
L_stage1:
    v_mov_b32 v106, s15
    ds_write_b32 v10, v106 offset:32
    s_mov_b32 exec_hi, -1
L_stage1b:
    s_mov_b32 m0, s25
    s_add_u32 s24, s15, 8192
    buffer_load_dwordx4 v117, s[16:19], s15 offen sc1 lds
    s_add_u32 m0, s25, 8192
    s_add_u32 s28, s15, 16384
    buffer_load_dwordx4 v117, s[16:19], s24 offen sc1 lds
    s_mov_b32 m0, s27
    s_cmp_ge_u32 s3, 3
    buffer_load_dwordx4 v117, s[16:19], s28 offen sc1 lds
    s_cbranch_scc1 L_no4
    s_add_u32 m0, s26, 8192
    s_add_u32 s28, s15, 24576
    buffer_load_dwordx4 v117, s[16:19], s28 offen sc1 lds
L_no4:
    s_mov_b64 exec, 1
    s_setprio 2
    s_waitcnt vmcnt(0)
    ds_add_u32 v10, v11 offset:24
    s_mov_b64 exec, -1
    s_movk_i32 s30, 16384
L_poll10:
    ds_read_b32 v162, v10 offset:24
    ds_read_b64_tr_b16 v[28:29], v2 offset:0
    ds_read_b64_tr_b16 v[30:31], v2 offset:128
    ds_read_b64_tr_b16 v[16:17], v112 offset:0
    ds_read_b64_tr_b16 v[18:19], v112 offset:128
    ds_read_b64_tr_b16 v[20:21], v112 offset:1152
    ds_read_b64_tr_b16 v[22:23], v112 offset:1280
    ds_read_b64_tr_b16 v[24:25], v114
    ds_read_b64_tr_b16 v[26:27], v3 offset:0
    s_waitcnt lgkmcnt(2)
    v_cmp_ne_u32 vcc, 8, v162
    s_cbranch_vccz L_ok11
    s_sub_u32 s30, s30, 1
    s_cmp_lg_u32 s30, 0
    s_cbranch_scc1 L_poll10
L_ok11:
    v_mfma_f32_32x32x16_bf16 v[72:87], v[28:31], v[16:19], 0
    v_mfma_f32_32x32x16_bf16 v[88:103], v[28:31], v[20:23], 0
    ds_read_b64_tr_b16 v[136:137], v2 offset:2304
    ds_read_b64_tr_b16 v[138:139], v2 offset:2432
    ds_read_b128 v[160:163], v4 offset:0
    ds_read_b128 v[164:167], v4 offset:1152
    s_waitcnt lgkmcnt(4)
    v_mov_b32 v25, 0
    s_nop 3
    v_mfma_f32_32x32x4_2b_bf16 v[72:103], v[26:27], v[24:25], v[72:103] cbsz:1 abid:0
    s_setprio 0
    s_nop 15
    s_nop 2
.p2align 6
L_att:
    v_exp_f32 v72, v72
    v_exp_f32 v73, v73
    v_exp_f32 v74, v74
    v_exp_f32 v75, v75
    v_exp_f32 v76, v76
    v_exp_f32 v77, v77
    v_exp_f32 v78, v78
    v_exp_f32 v79, v79
    v_exp_f32 v80, v80
    v_exp_f32 v81, v81
    v_exp_f32 v82, v82
    v_exp_f32 v83, v83
    v_exp_f32 v84, v84
    v_exp_f32 v85, v85
    v_exp_f32 v86, v86
    v_exp_f32 v87, v87
    v_exp_f32 v88, v88
    v_exp_f32 v89, v89
    s_setprio 1
    v_exp_f32 v90, v90
    v_exp_f32 v91, v91
    v_exp_f32 v92, v92
    v_exp_f32 v93, v93
    v_exp_f32 v94, v94
    v_exp_f32 v95, v95
    v_exp_f32 v96, v96
    v_exp_f32 v97, v97
    v_exp_f32 v98, v98
    v_exp_f32 v99, v99
    v_exp_f32 v100, v100
    v_exp_f32 v101, v101
    v_exp_f32 v102, v102
    v_exp_f32 v103, v103
    s_setprio 2
    s_waitcnt lgkmcnt(0)
    v_mfma_f32_32x32x4_2b_bf16 v[104:135], v[26:27], v[24:25], 0 cbsz:1 abid:1
    ds_read_b64_tr_b16 v[28:29], v2 offset:4608
    ds_read_b64_tr_b16 v[30:31], v2 offset:4736
    ds_read_b128 v[32:35], v4 offset:2304
    ds_read_b128 v[36:39], v4 offset:3456
    ds_read_b64_tr_b16 v[26:27], v3 offset:4608
    s_nop 1
    v_smfmac_f32_32x32x32_bf16 v[40:55], v[160:163], v[72:79], v6
    s_nop 4
    v_smfmac_f32_32x32x32_bf16 v[56:71], v[160:163], v[88:95], v6
    s_nop 3
    v_mfma_f32_32x32x16_bf16 v[104:119], v[136:139], v[16:19], v[104:119]
    s_nop 1
    v_mfma_f32_32x32x16_bf16 v[120:135], v[136:139], v[20:23], v[120:135]
    s_nop 2
    v_smfmac_f32_32x32x32_bf16 v[40:55], v[164:167], v[80:87], v6
    s_nop 2
    v_smfmac_f32_32x32x32_bf16 v[56:71], v[164:167], v[96:103], v6
    s_setprio 0
    v_exp_f32 v104, v104
    v_exp_f32 v105, v105
    v_exp_f32 v106, v106
    v_exp_f32 v107, v107
    v_exp_f32 v108, v108
    v_exp_f32 v109, v109
    v_exp_f32 v110, v110
    v_exp_f32 v111, v111
    v_exp_f32 v112, v112
    v_exp_f32 v113, v113
    v_exp_f32 v114, v114
    v_exp_f32 v115, v115
    v_exp_f32 v116, v116
    v_exp_f32 v117, v117
    v_exp_f32 v118, v118
    v_exp_f32 v119, v119
    v_exp_f32 v120, v120
    v_exp_f32 v121, v121
    s_setprio 1
    v_exp_f32 v122, v122
    v_exp_f32 v123, v123
    v_exp_f32 v124, v124
    v_exp_f32 v125, v125
    v_exp_f32 v126, v126
    v_exp_f32 v127, v127
    v_exp_f32 v128, v128
    v_exp_f32 v129, v129
    v_exp_f32 v130, v130
    v_exp_f32 v131, v131
    v_exp_f32 v132, v132
    v_exp_f32 v133, v133
    v_exp_f32 v134, v134
    v_exp_f32 v135, v135
    s_setprio 2
    s_waitcnt lgkmcnt(0)
    v_mfma_f32_32x32x4_2b_bf16 v[72:103], v[26:27], v[24:25], 0 cbsz:1 abid:0
    ds_read_b64_tr_b16 v[136:137], v2 offset:6912
    ds_read_b64_tr_b16 v[138:139], v2 offset:7040
    ds_read_b128 v[160:163], v4 offset:4608
    ds_read_b128 v[164:167], v4 offset:5760
    s_nop 2
    v_smfmac_f32_32x32x32_bf16 v[40:55], v[32:35], v[104:111], v6
    s_nop 4
    v_smfmac_f32_32x32x32_bf16 v[56:71], v[32:35], v[120:127], v6
    s_nop 3
    v_mfma_f32_32x32x16_bf16 v[72:87], v[28:31], v[16:19], v[72:87]
    s_nop 1
    v_mfma_f32_32x32x16_bf16 v[88:103], v[28:31], v[20:23], v[88:103]
    s_nop 2
    v_smfmac_f32_32x32x32_bf16 v[40:55], v[36:39], v[112:119], v6
    s_nop 2
    v_smfmac_f32_32x32x32_bf16 v[56:71], v[36:39], v[128:135], v6
    ds_read_b32 v158, v157 offset:64
    s_setprio 0
    v_exp_f32 v72, v72
    v_exp_f32 v73, v73
    v_exp_f32 v74, v74
    v_exp_f32 v75, v75
    v_exp_f32 v76, v76
    v_exp_f32 v77, v77
    v_exp_f32 v78, v78
    v_exp_f32 v79, v79
    v_exp_f32 v80, v80
    v_exp_f32 v81, v81
    v_exp_f32 v82, v82
    v_exp_f32 v83, v83
    v_exp_f32 v84, v84
    v_exp_f32 v85, v85
    v_exp_f32 v86, v86
    v_exp_f32 v87, v87
    v_exp_f32 v88, v88
    v_exp_f32 v89, v89
    s_setprio 1
    v_exp_f32 v90, v90
    v_exp_f32 v91, v91
    v_exp_f32 v92, v92
    v_exp_f32 v93, v93
    v_exp_f32 v94, v94
    v_exp_f32 v95, v95
    v_exp_f32 v96, v96
    v_exp_f32 v97, v97
    v_exp_f32 v98, v98
    v_exp_f32 v99, v99
    v_exp_f32 v100, v100
    v_exp_f32 v101, v101
    v_exp_f32 v102, v102
    v_exp_f32 v103, v103
    s_setprio 2
    s_waitcnt lgkmcnt(0)
    v_mfma_f32_32x32x4_2b_bf16 v[104:135], v[26:27], v[24:25], 0 cbsz:1 abid:1
    v_cmp_ge_u32 vcc, s14, v158
    s_nop 0
    s_cbranch_vccnz L_att_wait
L_att_back:
    ds_read_b64_tr_b16 v[28:29], v2 offset:18432
    ds_read_b64_tr_b16 v[30:31], v2 offset:18560
    ds_read_b128 v[32:35], v4 offset:6912
    ds_read_b128 v[36:39], v4 offset:8064
    ds_read_b64_tr_b16 v[26:27], v3 offset:18432
    v_smfmac_f32_32x32x32_bf16 v[40:55], v[160:163], v[72:79], v6
    s_nop 4
    v_smfmac_f32_32x32x32_bf16 v[56:71], v[160:163], v[88:95], v6
    s_nop 3
    v_mfma_f32_32x32x16_bf16 v[104:119], v[136:139], v[16:19], v[104:119]
    s_cmp_eq_u32 s14, 6
    s_nop 0
    v_mfma_f32_32x32x16_bf16 v[120:135], v[136:139], v[20:23], v[120:135]
    s_nop 2
    v_smfmac_f32_32x32x32_bf16 v[40:55], v[164:167], v[80:87], v6
    s_nop 2
    v_smfmac_f32_32x32x32_bf16 v[56:71], v[164:167], v[96:103], v6
    s_setprio 0
    v_exp_f32 v104, v104
    v_exp_f32 v105, v105
    v_exp_f32 v106, v106
    v_exp_f32 v107, v107
    v_exp_f32 v108, v108
    v_exp_f32 v109, v109
    v_exp_f32 v110, v110
    v_exp_f32 v111, v111
    v_exp_f32 v112, v112
    v_exp_f32 v113, v113
    v_exp_f32 v114, v114
    v_exp_f32 v115, v115
    v_exp_f32 v116, v116
    v_exp_f32 v117, v117
    v_exp_f32 v118, v118
    v_exp_f32 v119, v119
    v_exp_f32 v120, v120
    v_exp_f32 v121, v121
    s_setprio 1
    v_exp_f32 v122, v122
    v_exp_f32 v123, v123
    v_exp_f32 v124, v124
    v_exp_f32 v125, v125
    v_exp_f32 v126, v126
    v_exp_f32 v127, v127
    v_exp_f32 v128, v128
    v_exp_f32 v129, v129
    v_exp_f32 v130, v130
    v_exp_f32 v131, v131
    v_exp_f32 v132, v132
    v_exp_f32 v133, v133
    v_exp_f32 v134, v134
    v_exp_f32 v135, v135
    s_setprio 2
    s_waitcnt lgkmcnt(0)
    s_cbranch_scc1 L_last
    v_mfma_f32_32x32x4_2b_bf16 v[72:103], v[26:27], v[24:25], 0 cbsz:1 abid:0
    v_add_u32 v2, 18432, v2
    v_add_u32 v4, v5, v4
    ds_read_b64_tr_b16 v[136:137], v2 offset:2304
    ds_read_b64_tr_b16 v[138:139], v2 offset:2432
    ds_read_b128 v[160:163], v4 offset:0
    ds_read_b128 v[164:167], v4 offset:1152
    ds_add_u32 v156, v11
    v_smfmac_f32_32x32x32_bf16 v[40:55], v[32:35], v[104:111], v6
    s_nop 4
    v_smfmac_f32_32x32x32_bf16 v[56:71], v[32:35], v[120:127], v6
    s_nop 3
    v_mfma_f32_32x32x16_bf16 v[72:87], v[28:31], v[16:19], v[72:87]
    s_add_u32 s14, s14, 1
    v_add_u32 v3, 18432, v3
    v_mfma_f32_32x32x16_bf16 v[88:103], v[28:31], v[20:23], v[88:103]
    s_nop 2
    v_smfmac_f32_32x32x32_bf16 v[40:55], v[36:39], v[112:119], v6
    s_nop 2
    v_smfmac_f32_32x32x32_bf16 v[56:71], v[36:39], v[128:135], v6
    s_setprio 0
    s_branch L_att
L_last:
    ds_read_b64_tr_b16 v[136:137], v2 offset:20736
    ds_read_b64_tr_b16 v[138:139], v2 offset:20864
    v_mfma_f32_32x32x16_bf16 v[72:87], v[28:31], v[16:19], 0
    ds_add_u32 v156, v11
    v_add_u32 v2, 18432, v2
    v_add_u32 v4, v5, v4
    v_mov_b32 v8, v24
    v_mov_b32 v159, v24
    v_smfmac_f32_32x32x32_bf16 v[40:55], v[32:35], v[104:111], v6
    ds_read_b64_tr_b16 v[28:29], v2 offset:4608
    ds_read_b64_tr_b16 v[30:31], v2 offset:4736
    v_mov_b32 v9, 0
    v_permlane32_swap_b32 v24, v8
    v_smfmac_f32_32x32x32_bf16 v[56:71], v[32:35], v[120:127], v6
    ds_read_b128 v[32:35], v4 offset:0
    ds_read_b128 v[160:163], v4 offset:2304
    s_waitcnt lgkmcnt(5)
    v_mfma_f32_32x32x16_bf16 v[88:103], v[136:139], v[16:19], 0
    ds_read_b64_tr_b16 v[136:137], v2 offset:6912
    ds_read_b64_tr_b16 v[138:139], v2 offset:7040
    ds_read_b128 v[164:167], v4 offset:3456
    s_mov_b32 s14, 7
    v_smfmac_f32_32x32x32_bf16 v[40:55], v[36:39], v[112:119], v6
    v_add_u32 v3, 18432, v3
    s_nop 3
    v_mfma_f32_32x32x4_2b_bf16 v[72:103], v[26:27], v[24:25], v[72:103]
    ds_read_b64_tr_b16 v[26:27], v3 offset:4608
    s_nop 15
    v_smfmac_f32_32x32x32_bf16 v[56:71], v[36:39], v[128:135], v6
    ds_read_b128 v[36:39], v4 offset:1152
    s_setprio 0
    v_exp_f32 v72, v72
    v_exp_f32 v73, v73
    v_exp_f32 v74, v74
    v_exp_f32 v75, v75
    v_exp_f32 v76, v76
    v_exp_f32 v77, v77
    v_exp_f32 v78, v78
    v_exp_f32 v79, v79
    v_exp_f32 v80, v80
    v_exp_f32 v81, v81
    v_exp_f32 v82, v82
    v_exp_f32 v83, v83
    v_exp_f32 v84, v84
    v_exp_f32 v85, v85
    v_exp_f32 v86, v86
    v_exp_f32 v87, v87
    v_exp_f32 v88, v88
    v_exp_f32 v89, v89
    s_setprio 1
    v_exp_f32 v90, v90
    v_exp_f32 v91, v91
    v_exp_f32 v92, v92
    v_exp_f32 v93, v93
    v_exp_f32 v94, v94
    v_exp_f32 v95, v95
    v_exp_f32 v96, v96
    v_exp_f32 v97, v97
    v_exp_f32 v98, v98
    v_exp_f32 v99, v99
    v_exp_f32 v100, v100
    v_exp_f32 v101, v101
    v_exp_f32 v102, v102
    v_exp_f32 v103, v103
    s_setprio 2
    s_waitcnt lgkmcnt(0)
    v_mfma_f32_32x32x16_bf16 v[104:119], v[28:31], v[16:19], 0
    ds_read_b64_tr_b16 v[28:29], v2 offset:0
    ds_read_b64_tr_b16 v[30:31], v2 offset:128
    v_mfma_f32_32x32x16_bf16 v[120:135], v[136:139], v[16:19], 0
    ds_read_b64_tr_b16 v[136:137], v2 offset:2304
    ds_read_b64_tr_b16 v[138:139], v2 offset:2432
    s_nop 2
    v_smfmac_f32_32x32x32_bf16 v[40:55], v[32:35], v[72:79], v6
    ds_read_b128 v[32:35], v4 offset:4608
    s_nop 2
    v_mfma_f32_32x32x4_2b_bf16 v[104:135], v[26:27], v[24:25], v[104:135]
    ds_read_b64_tr_b16 v[26:27], v3 offset:0
    s_nop 9
    v_smfmac_f32_32x32x32_bf16 v[40:55], v[36:39], v[80:87], v6
    ds_read_b128 v[36:39], v4 offset:5760
    s_nop 0
    v_smfmac_f32_32x32x32_bf16 v[40:55], v[160:163], v[88:95], v6
    ds_read_b128 v[160:163], v4 offset:6912
    s_nop 0
    v_smfmac_f32_32x32x32_bf16 v[40:55], v[164:167], v[96:103], v6
    ds_read_b128 v[164:167], v4 offset:8064
    ds_read_b32 v158, v157 offset:64
    s_setprio 0
    v_exp_f32 v104, v104
    v_exp_f32 v105, v105
    v_exp_f32 v106, v106
    v_exp_f32 v107, v107
    v_exp_f32 v108, v108
    v_exp_f32 v109, v109
    v_exp_f32 v110, v110
    v_exp_f32 v111, v111
    v_exp_f32 v112, v112
    v_exp_f32 v113, v113
    v_exp_f32 v114, v114
    v_exp_f32 v115, v115
    v_exp_f32 v116, v116
    v_exp_f32 v117, v117
    v_exp_f32 v118, v118
    v_exp_f32 v119, v119
    v_exp_f32 v120, v120
    v_exp_f32 v121, v121
    s_setprio 1
    v_exp_f32 v122, v122
    v_exp_f32 v123, v123
    v_exp_f32 v124, v124
    v_exp_f32 v125, v125
    v_exp_f32 v126, v126
    v_exp_f32 v127, v127
    v_exp_f32 v128, v128
    v_exp_f32 v129, v129
    v_exp_f32 v130, v130
    v_exp_f32 v131, v131
    v_exp_f32 v132, v132
    v_exp_f32 v133, v133
    v_exp_f32 v134, v134
    v_exp_f32 v135, v135
    s_setprio 2
    s_waitcnt lgkmcnt(0)
    v_mfma_f32_32x32x16_bf16 v[72:87], v[28:31], v[20:23], 0
    v_cmp_ge_u32 vcc, s14, v158
    ds_read_b64_tr_b16 v[28:29], v2 offset:4608
    ds_read_b64_tr_b16 v[30:31], v2 offset:4736
    v_mfma_f32_32x32x16_bf16 v[88:103], v[136:139], v[20:23], 0
    s_cbranch_vccnz L_att_wait2
L_att_back2:
    ds_read_b64_tr_b16 v[136:137], v2 offset:6912
    ds_read_b64_tr_b16 v[138:139], v2 offset:7040
    s_nop 2
    v_smfmac_f32_32x32x32_bf16 v[40:55], v[32:35], v[104:111], v6
    ds_read_b128 v[32:35], v4 offset:0
    s_nop 2
    v_mfma_f32_32x32x4_2b_bf16 v[72:103], v[26:27], v[8:9], v[72:103]
    ds_read_b64_tr_b16 v[26:27], v3 offset:4608
    s_nop 9
    v_smfmac_f32_32x32x32_bf16 v[40:55], v[36:39], v[112:119], v6
    ds_read_b128 v[36:39], v4 offset:1152
    s_nop 0
    v_smfmac_f32_32x32x32_bf16 v[40:55], v[160:163], v[120:127], v6
    ds_read_b128 v[160:163], v4 offset:2304
    s_nop 0
    v_smfmac_f32_32x32x32_bf16 v[40:55], v[164:167], v[128:135], v6
    ds_read_b128 v[164:167], v4 offset:3456
    s_cmp_lg_u32 s12, 0
    s_setprio 0
    v_exp_f32 v72, v72
    v_exp_f32 v73, v73
    v_exp_f32 v74, v74
    v_exp_f32 v75, v75
    v_exp_f32 v76, v76
    v_exp_f32 v77, v77
    v_exp_f32 v78, v78
    v_exp_f32 v79, v79
    v_exp_f32 v80, v80
    v_exp_f32 v81, v81
    s_cbranch_scc1 L_second
    ds_write_b128 v140, v[40:43]
    ds_write_b128 v140, v[44:47] offset:1024
    ds_write_b64 v141, v[48:49] offset:2048
    ds_add_u32 v156, v11 offset:64
    v_exp_f32 v82, v82
    v_exp_f32 v83, v83
    v_exp_f32 v84, v84
    v_exp_f32 v85, v85
    v_exp_f32 v86, v86
    v_exp_f32 v87, v87
    v_exp_f32 v88, v88
    v_exp_f32 v89, v89
    s_setprio 1
    v_exp_f32 v90, v90
    v_exp_f32 v91, v91
    v_exp_f32 v92, v92
    v_exp_f32 v93, v93
    v_exp_f32 v94, v94
    v_exp_f32 v95, v95
    v_exp_f32 v96, v96
    v_exp_f32 v97, v97
    v_exp_f32 v98, v98
    v_exp_f32 v99, v99
    v_exp_f32 v100, v100
    v_exp_f32 v101, v101
    v_exp_f32 v102, v102
    v_exp_f32 v103, v103
    s_setprio 2
    s_waitcnt lgkmcnt(0)
    v_mfma_f32_32x32x16_bf16 v[104:119], v[28:31], v[20:23], 0
    v_mfma_f32_32x32x16_bf16 v[120:135], v[136:139], v[20:23], 0
    s_nop 4
    v_smfmac_f32_32x32x32_bf16 v[56:71], v[32:35], v[72:79], v6
    ds_read_b128 v[32:35], v4 offset:4608
    s_nop 2
    v_mfma_f32_32x32x4_2b_bf16 v[104:135], v[26:27], v[8:9], v[104:135]
    s_nop 10
    v_smfmac_f32_32x32x32_bf16 v[56:71], v[36:39], v[80:87], v6
    ds_read_b128 v[36:39], v4 offset:5760
    s_nop 0
    v_smfmac_f32_32x32x32_bf16 v[56:71], v[160:163], v[88:95], v6
    ds_read_b128 v[160:163], v4 offset:6912
    s_nop 0
    v_smfmac_f32_32x32x32_bf16 v[56:71], v[164:167], v[96:103], v6
    ds_read_b128 v[164:167], v4 offset:8064
    s_setprio 0
    v_exp_f32 v104, v104
    v_exp_f32 v105, v105
    v_exp_f32 v106, v106
    v_exp_f32 v107, v107
    v_exp_f32 v108, v108
    v_exp_f32 v109, v109
    v_exp_f32 v110, v110
    v_exp_f32 v111, v111
    v_exp_f32 v112, v112
    v_exp_f32 v113, v113
    v_exp_f32 v114, v114
    v_exp_f32 v115, v115
    v_exp_f32 v116, v116
    v_exp_f32 v117, v117
    v_exp_f32 v118, v118
    v_exp_f32 v119, v119
    v_exp_f32 v120, v120
    v_exp_f32 v121, v121
    s_setprio 1
    v_exp_f32 v122, v122
    v_exp_f32 v123, v123
    v_exp_f32 v124, v124
    v_exp_f32 v125, v125
    v_exp_f32 v126, v126
    v_exp_f32 v127, v127
    v_exp_f32 v128, v128
    v_exp_f32 v129, v129
    s_waitcnt lgkmcnt(0)
    v_smfmac_f32_32x32x32_bf16 v[56:71], v[32:35], v[104:111], v6
    v_exp_f32 v130, v130
    v_exp_f32 v131, v131
    v_exp_f32 v132, v132
    v_smfmac_f32_32x32x32_bf16 v[56:71], v[36:39], v[112:119], v6
    v_exp_f32 v133, v133
    v_exp_f32 v134, v134
    v_exp_f32 v135, v135
    s_setprio 2
    v_smfmac_f32_32x32x32_bf16 v[56:71], v[160:163], v[120:127], v6
    v_smfmac_f32_32x32x32_bf16 v[56:71], v[164:167], v[128:135], v6
    s_nop 11
    ds_write_b128 v142, v[56:59]
    ds_write_b128 v142, v[60:63] offset:1024
    ds_write_b64 v143, v[64:65] offset:2048
    ds_add_u32 v156, v11 offset:64
    s_waitcnt lgkmcnt(0)
    s_branch L_stored
L_second:
    ds_read_b32 v158, v148
    ds_read_b64 v[50:51], v141 offset:2048
    ds_read_b128 v[12:15], v140
    ds_read_b128 v[52:55], v140 offset:1024
    v_exp_f32 v82, v82
    v_exp_f32 v83, v83
    v_exp_f32 v84, v84
    v_exp_f32 v85, v85
    v_exp_f32 v86, v86
    v_exp_f32 v87, v87
    v_exp_f32 v88, v88
    v_exp_f32 v89, v89
    s_setprio 1
    v_exp_f32 v90, v90
    v_exp_f32 v91, v91
    s_waitcnt lgkmcnt(0)
    v_cmp_gt_u32 vcc, 1, v158
    s_cbranch_vccnz L_retry0
L_got0:
    v_add_f32 v49, v51, v49
    v_add_f32 v48, v50, v48
    v_rcp_f32 v50, v49
    v_subrev_u32 v158, 729808896, v49
    v_mul_f32 v48, v48, v50
    v_mov_b32 v49, v48
    v_cmp_lt_u32 vcc, 671088640, v158
    v_pk_add_f32 v[40:41], v[12:13], v[40:41]
    v_pk_add_f32 v[42:43], v[14:15], v[42:43]
    v_pk_add_f32 v[44:45], v[52:53], v[44:45]
    v_pk_add_f32 v[46:47], v[54:55], v[46:47]
    v_permlane32_swap_b32 v48, v49
    v_pk_mul_f32 v[40:41], v[40:41], v[50:51] op_sel_hi:[1,0]
    v_pk_mul_f32 v[42:43], v[42:43], v[50:51] op_sel_hi:[1,0]
    v_pk_mul_f32 v[44:45], v[44:45], v[50:51] op_sel_hi:[1,0]
    v_pk_mul_f32 v[46:47], v[46:47], v[50:51] op_sel_hi:[1,0]
    v_cvt_pk_bf16_f32 v40, v40, v41
    v_cvt_pk_bf16_f32 v41, v42, v43
    v_cvt_pk_bf16_f32 v42, v44, v45
    v_cvt_pk_bf16_f32 v43, v46, v47
    v_cvt_pk_bf16_f32 v44, v48, v49
    v_min_u32 v40, -2, v40
    v_min_u32 v41, -2, v41
    v_min_u32 v42, -2, v42
    v_min_u32 v43, -2, v43
    v_min_u32 v44, -2, v44
    s_cbranch_vccnz L_bad0
    buffer_store_dwordx4 v[40:43], v144, s[16:19], s52 offen sc1
    buffer_store_dword v44, v145, s[16:19], s53 offen sc1
L_nostore0:
    v_exp_f32 v92, v92
    v_exp_f32 v93, v93
    v_exp_f32 v94, v94
    v_exp_f32 v95, v95
    v_exp_f32 v96, v96
    v_exp_f32 v97, v97
    v_exp_f32 v98, v98
    v_exp_f32 v99, v99
    v_exp_f32 v100, v100
    v_exp_f32 v101, v101
    v_exp_f32 v102, v102
    v_exp_f32 v103, v103
    s_setprio 2
    s_waitcnt lgkmcnt(0)
    v_mfma_f32_32x32x16_bf16 v[104:119], v[28:31], v[20:23], 0
    v_mfma_f32_32x32x16_bf16 v[120:135], v[136:139], v[20:23], 0
    s_nop 4
    v_smfmac_f32_32x32x32_bf16 v[56:71], v[32:35], v[72:79], v6
    ds_read_b128 v[32:35], v4 offset:4608
    s_nop 2
    v_mfma_f32_32x32x4_2b_bf16 v[104:135], v[26:27], v[8:9], v[104:135]
    s_nop 10
    v_smfmac_f32_32x32x32_bf16 v[56:71], v[36:39], v[80:87], v6
    ds_read_b128 v[36:39], v4 offset:5760
    s_nop 0
    v_smfmac_f32_32x32x32_bf16 v[56:71], v[160:163], v[88:95], v6
    ds_read_b128 v[160:163], v4 offset:6912
    s_nop 0
    v_smfmac_f32_32x32x32_bf16 v[56:71], v[164:167], v[96:103], v6
    ds_read_b128 v[164:167], v4 offset:8064
    s_setprio 0
    v_exp_f32 v104, v104
    v_exp_f32 v105, v105
    v_exp_f32 v106, v106
    v_exp_f32 v107, v107
    v_exp_f32 v108, v108
    v_exp_f32 v109, v109
    v_exp_f32 v110, v110
    v_exp_f32 v111, v111
    v_exp_f32 v112, v112
    v_exp_f32 v113, v113
    v_exp_f32 v114, v114
    v_exp_f32 v115, v115
    v_exp_f32 v116, v116
    v_exp_f32 v117, v117
    v_exp_f32 v118, v118
    v_exp_f32 v119, v119
    v_exp_f32 v120, v120
    v_exp_f32 v121, v121
    s_setprio 1
    s_waitcnt lgkmcnt(0)
    v_smfmac_f32_32x32x32_bf16 v[56:71], v[32:35], v[104:111], v6
    v_exp_f32 v122, v122
    v_exp_f32 v123, v123
    v_exp_f32 v124, v124
    v_smfmac_f32_32x32x32_bf16 v[56:71], v[36:39], v[112:119], v6
    v_exp_f32 v125, v125
    v_exp_f32 v126, v126
    v_exp_f32 v127, v127
    v_exp_f32 v128, v128
    v_exp_f32 v129, v129
    v_exp_f32 v130, v130
    v_exp_f32 v131, v131
    v_smfmac_f32_32x32x32_bf16 v[56:71], v[160:163], v[120:127], v6
    v_exp_f32 v132, v132
    v_exp_f32 v133, v133
    v_exp_f32 v134, v134
    v_exp_f32 v135, v135
    ds_read_b32 v158, v148
    ds_read_b64 v[80:81], v143 offset:2048
    ds_read_b128 v[72:75], v142
    ds_read_b128 v[76:79], v142 offset:1024
    v_smfmac_f32_32x32x32_bf16 v[56:71], v[164:167], v[128:135], v6
    s_waitcnt lgkmcnt(0)
    v_cmp_gt_u32 vcc, 2, v158
    s_cbranch_vccnz L_retry1
L_got1:
    s_nop 8
    v_add_f32 v65, v81, v65
    v_add_f32 v64, v80, v64
    v_rcp_f32 v80, v65
    v_subrev_u32 v158, 729808896, v65
    v_mul_f32 v64, v64, v80
    v_mov_b32 v65, v64
    v_cmp_lt_u32 vcc, 671088640, v158
    v_pk_add_f32 v[56:57], v[72:73], v[56:57]
    v_pk_add_f32 v[58:59], v[74:75], v[58:59]
    v_pk_add_f32 v[60:61], v[76:77], v[60:61]
    v_pk_add_f32 v[62:63], v[78:79], v[62:63]
    v_permlane32_swap_b32 v64, v65
    v_pk_mul_f32 v[56:57], v[56:57], v[80:81] op_sel_hi:[1,0]
    v_pk_mul_f32 v[58:59], v[58:59], v[80:81] op_sel_hi:[1,0]
    v_pk_mul_f32 v[60:61], v[60:61], v[80:81] op_sel_hi:[1,0]
    v_pk_mul_f32 v[62:63], v[62:63], v[80:81] op_sel_hi:[1,0]
    v_cvt_pk_bf16_f32 v56, v56, v57
    v_cvt_pk_bf16_f32 v57, v58, v59
    v_cvt_pk_bf16_f32 v58, v60, v61
    v_cvt_pk_bf16_f32 v59, v62, v63
    v_cvt_pk_bf16_f32 v60, v64, v65
    v_min_u32 v56, -2, v56
    v_min_u32 v57, -2, v57
    v_min_u32 v58, -2, v58
    v_min_u32 v59, -2, v59
    v_min_u32 v60, -2, v60
    s_cbranch_vccnz L_bad1
    s_add_u32 s24, s52, 32768
    s_add_u32 s25, s53, 4096
    buffer_store_dwordx4 v[56:59], v144, s[16:19], s24 offen sc1
    buffer_store_dword v60, v145, s[16:19], s25 offen sc1
L_nostore1:
L_stored:
    s_setprio 0
    buffer_load_dwordx4 v[12:15], v7, s[8:11], 0 offen
    s_barrier
    ds_read_b32 v164, v10 offset:8
    ds_read_b32 v8, v153 offset:6144
    ds_read_b64 v[162:163], v10 offset:16
    s_movk_i32 s54, 1024
    s_waitcnt lgkmcnt(2)
    v_cmp_lt_u32 vcc, s61, v164
    s_cbranch_vccnz L_fallback
L_oproj:
    buffer_load_dword v48, v150, s[16:19], s56 offen offset:0 sc1
    buffer_load_dword v49, v150, s[16:19], s56 offen offset:128 sc1
    buffer_load_dword v50, v150, s[16:19], s56 offen offset:256 sc1
    buffer_load_dword v51, v150, s[16:19], s56 offen offset:384 sc1
    ds_read_b64_tr_b16 v[80:81], v147 offset:0
    ds_read_b64_tr_b16 v[82:83], v147 offset:5760
    ds_read_b64_tr_b16 v[84:85], v147 offset:32
    ds_read_b64_tr_b16 v[86:87], v147 offset:5792
    ds_read_b64_tr_b16 v[88:89], v147 offset:64
    ds_read_b64_tr_b16 v[90:91], v147 offset:5824
    ds_read_b64_tr_b16 v[92:93], v147 offset:96
    ds_read_b64_tr_b16 v[94:95], v147 offset:5856
    ds_read_b64_tr_b16 v[96:97], v147 offset:128
    ds_read_b64_tr_b16 v[98:99], v147 offset:5888
    ds_read_b64_tr_b16 v[100:101], v146 offset:0
    ds_read_b64_tr_b16 v[102:103], v146 offset:1280
    ds_read_b64_tr_b16 v[104:105], v146 offset:32
    ds_read_b64_tr_b16 v[106:107], v146 offset:1312
    ds_read_b64_tr_b16 v[108:109], v146 offset:64
    ds_read_b64_tr_b16 v[110:111], v146 offset:1344
    ds_read_b64_tr_b16 v[112:113], v146 offset:96
    ds_read_b64_tr_b16 v[114:115], v146 offset:1376
    ds_read_b64_tr_b16 v[116:117], v146 offset:128
    ds_read_b64_tr_b16 v[118:119], v146 offset:1408
    ds_read_b64_tr_b16 v[120:121], v146 offset:5760
    ds_read_b64_tr_b16 v[122:123], v146 offset:7040
    ds_read_b64_tr_b16 v[124:125], v146 offset:5792
    ds_read_b64_tr_b16 v[126:127], v146 offset:7072
    ds_read_b64_tr_b16 v[128:129], v146 offset:5824
    ds_read_b64_tr_b16 v[130:131], v146 offset:7104
    ds_read_b64_tr_b16 v[132:133], v146 offset:5856
    ds_read_b64_tr_b16 v[134:135], v146 offset:7136
    ds_read_b64_tr_b16 v[136:137], v146 offset:5888
    ds_read_b64_tr_b16 v[138:139], v146 offset:7168
    s_movk_i32 s30, 16384
    s_branch L_chk17
L_poll15:
    buffer_load_dword v48, v150, s[16:19], s56 offen offset:0 sc1
    buffer_load_dword v49, v150, s[16:19], s56 offen offset:128 sc1
    buffer_load_dword v50, v150, s[16:19], s56 offen offset:256 sc1
    buffer_load_dword v51, v150, s[16:19], s56 offen offset:384 sc1
L_chk17:
    s_waitcnt vmcnt(0)
    v_max3_u32 v165, v48, v49, v50
    v_max_u32 v165, v165, v51
    v_cmp_eq_u32 vcc, -1, v165
    s_cbranch_vccz L_ok16
    s_sub_u32 s30, s30, 1
    s_cmp_lg_u32 s30, 0
    s_cbranch_scc1 L_poll15
L_ok16:
    buffer_load_dwordx4 v[16:19], v149, s[16:19], s55 offen offset:0 sc1
    buffer_load_dwordx4 v[20:23], v149, s[16:19], s55 offen offset:2048 sc1
    buffer_load_dwordx4 v[24:27], v149, s[16:19], s57 offen offset:0 sc1
    buffer_load_dwordx4 v[28:31], v149, s[16:19], s57 offen offset:2048 sc1
    buffer_load_dwordx4 v[32:35], v149, s[16:19], s58 offen offset:0 sc1
    buffer_load_dwordx4 v[36:39], v149, s[16:19], s58 offen offset:2048 sc1
    buffer_load_dwordx4 v[40:43], v149, s[16:19], s59 offen offset:0 sc1
    buffer_load_dwordx4 v[44:47], v149, s[16:19], s59 offen offset:2048 sc1
    s_waitcnt lgkmcnt(0)
    v_lshlrev_b32 v72, 16, v12
    v_and_b32 v73, 0xffff0000, v12
    v_lshlrev_b32 v74, 16, v13
    v_and_b32 v75, 0xffff0000, v13
    v_lshlrev_b32 v76, 16, v14
    v_and_b32 v77, 0xffff0000, v14
    v_lshlrev_b32 v78, 16, v15
    v_and_b32 v79, 0xffff0000, v15
    v_sub_f32 v160, 1.0, v8
    v_cvt_pk_bf16_f32 v160, v160, v160
    v_and_b32 v160, 0xffff0000, v160
    v_and_b32 v162, 0x7ff, v162
    v_and_b32 v163, 0x7ff, v163
    v_cmp_eq_u32 s[26:27], v162, v154
    v_cmp_eq_u32 s[28:29], v163, v154
    v_pk_mul_f32 v[72:73], v[72:73], v[160:161] op_sel_hi:[1,0]
    v_pk_mul_f32 v[74:75], v[74:75], v[160:161] op_sel_hi:[1,0]
    v_pk_mul_f32 v[76:77], v[76:77], v[160:161] op_sel_hi:[1,0]
    v_pk_mul_f32 v[78:79], v[78:79], v[160:161] op_sel_hi:[1,0]
    s_or_b64 s[26:27], s[26:27], s[28:29]
    s_mov_b32 s8, s50
    s_mov_b32 s9, s51
    s_waitcnt vmcnt(8) lgkmcnt(0)
    v_mfma_f32_16x16x32_bf16 v[52:55], v[80:83], v[48:51], 0
    ds_read_b64_tr_b16 v[80:81], v146 offset:11520
    ds_read_b64_tr_b16 v[82:83], v146 offset:12800
    v_mfma_f32_16x16x32_bf16 v[56:59], v[84:87], v[48:51], 0
    ds_read_b64_tr_b16 v[84:85], v146 offset:11552
    ds_read_b64_tr_b16 v[86:87], v146 offset:12832
    v_mfma_f32_16x16x32_bf16 v[60:63], v[88:91], v[48:51], 0
    ds_read_b64_tr_b16 v[88:89], v146 offset:11584
    ds_read_b64_tr_b16 v[90:91], v146 offset:12864
    v_mfma_f32_16x16x32_bf16 v[64:67], v[92:95], v[48:51], 0
    ds_read_b64_tr_b16 v[92:93], v146 offset:11616
    ds_read_b64_tr_b16 v[94:95], v146 offset:12896
    v_mfma_f32_16x16x32_bf16 v[68:71], v[96:99], v[48:51], 0
    ds_read_b64_tr_b16 v[96:97], v146 offset:11648
    ds_read_b64_tr_b16 v[98:99], v146 offset:12928
    s_waitcnt vmcnt(7) lgkmcnt(15)
    v_mfma_f32_16x16x32_bf16 v[52:55], v[100:103], v[16:19], v[52:55]
    ds_read_b64_tr_b16 v[100:101], v146 offset:17280
    ds_read_b64_tr_b16 v[102:103], v146 offset:18560
    v_max3_u32 v165, v16, v17, v165
    v_mfma_f32_16x16x32_bf16 v[56:59], v[104:107], v[16:19], v[56:59]
    ds_read_b64_tr_b16 v[104:105], v146 offset:17312
    ds_read_b64_tr_b16 v[106:107], v146 offset:18592
    v_max3_u32 v165, v18, v19, v165
    v_mfma_f32_16x16x32_bf16 v[60:63], v[108:111], v[16:19], v[60:63]
    ds_read_b64_tr_b16 v[108:109], v146 offset:17344
    ds_read_b64_tr_b16 v[110:111], v146 offset:18624
    v_mfma_f32_16x16x32_bf16 v[64:67], v[112:115], v[16:19], v[64:67]
    ds_read_b64_tr_b16 v[112:113], v146 offset:17376
    ds_read_b64_tr_b16 v[114:115], v146 offset:18656
    v_mfma_f32_16x16x32_bf16 v[68:71], v[116:119], v[16:19], v[68:71]
    ds_read_b64_tr_b16 v[116:117], v146 offset:17408
    ds_read_b64_tr_b16 v[118:119], v146 offset:18688
    s_waitcnt vmcnt(6) lgkmcnt(15)
    v_mfma_f32_16x16x32_bf16 v[52:55], v[120:123], v[20:23], v[52:55]
    ds_read_b64_tr_b16 v[120:121], v146 offset:23040
    ds_read_b64_tr_b16 v[122:123], v146 offset:24320
    v_max3_u32 v165, v20, v21, v165
    v_mfma_f32_16x16x32_bf16 v[56:59], v[124:127], v[20:23], v[56:59]
    ds_read_b64_tr_b16 v[124:125], v146 offset:23072
    ds_read_b64_tr_b16 v[126:127], v146 offset:24352
    v_max3_u32 v165, v22, v23, v165
    v_mfma_f32_16x16x32_bf16 v[60:63], v[128:131], v[20:23], v[60:63]
    ds_read_b64_tr_b16 v[128:129], v146 offset:23104
    ds_read_b64_tr_b16 v[130:131], v146 offset:24384
    v_mfma_f32_16x16x32_bf16 v[64:67], v[132:135], v[20:23], v[64:67]
    ds_read_b64_tr_b16 v[132:133], v146 offset:23136
    ds_read_b64_tr_b16 v[134:135], v146 offset:24416
    v_mfma_f32_16x16x32_bf16 v[68:71], v[136:139], v[20:23], v[68:71]
    ds_read_b64_tr_b16 v[136:137], v146 offset:23168
    ds_read_b64_tr_b16 v[138:139], v146 offset:24448
    s_waitcnt vmcnt(5) lgkmcnt(14)
    v_mfma_f32_16x16x32_bf16 v[52:55], v[80:83], v[24:27], v[52:55]
    ds_read_b64_tr_b16 v[80:81], v146 offset:28800
    ds_read_b64_tr_b16 v[82:83], v146 offset:30080
    v_max3_u32 v165, v24, v25, v165
    v_mfma_f32_16x16x32_bf16 v[56:59], v[84:87], v[24:27], v[56:59]
    ds_read_b64_tr_b16 v[84:85], v146 offset:28832
    ds_read_b64_tr_b16 v[86:87], v146 offset:30112
    v_max3_u32 v165, v26, v27, v165
    v_mfma_f32_16x16x32_bf16 v[60:63], v[88:91], v[24:27], v[60:63]
    ds_read_b64_tr_b16 v[88:89], v146 offset:28864
    ds_read_b64_tr_b16 v[90:91], v146 offset:30144
    v_mfma_f32_16x16x32_bf16 v[64:67], v[92:95], v[24:27], v[64:67]
    ds_read_b64_tr_b16 v[92:93], v146 offset:28896
    ds_read_b64_tr_b16 v[94:95], v146 offset:30176
    v_mfma_f32_16x16x32_bf16 v[68:71], v[96:99], v[24:27], v[68:71]
    ds_read_b64_tr_b16 v[96:97], v146 offset:28928
    ds_read_b64_tr_b16 v[98:99], v146 offset:30208
    s_waitcnt vmcnt(4) lgkmcnt(14)
    v_mfma_f32_16x16x32_bf16 v[52:55], v[100:103], v[28:31], v[52:55]
    ds_read_b64_tr_b16 v[100:101], v146 offset:34560
    ds_read_b64_tr_b16 v[102:103], v146 offset:35840
    v_max3_u32 v165, v28, v29, v165
    v_mfma_f32_16x16x32_bf16 v[56:59], v[104:107], v[28:31], v[56:59]
    ds_read_b64_tr_b16 v[104:105], v146 offset:34592
    ds_read_b64_tr_b16 v[106:107], v146 offset:35872
    v_max3_u32 v165, v30, v31, v165
    v_mfma_f32_16x16x32_bf16 v[60:63], v[108:111], v[28:31], v[60:63]
    ds_read_b64_tr_b16 v[108:109], v146 offset:34624
    ds_read_b64_tr_b16 v[110:111], v146 offset:35904
    v_mfma_f32_16x16x32_bf16 v[64:67], v[112:115], v[28:31], v[64:67]
    ds_read_b64_tr_b16 v[112:113], v146 offset:34656
    ds_read_b64_tr_b16 v[114:115], v146 offset:35936
    v_mfma_f32_16x16x32_bf16 v[68:71], v[116:119], v[28:31], v[68:71]
    ds_read_b64_tr_b16 v[116:117], v146 offset:34688
    ds_read_b64_tr_b16 v[118:119], v146 offset:35968
    s_waitcnt vmcnt(3) lgkmcnt(14)
    v_mfma_f32_16x16x32_bf16 v[52:55], v[120:123], v[32:35], v[52:55]
    ds_read_b64_tr_b16 v[120:121], v146 offset:40320
    ds_read_b64_tr_b16 v[122:123], v146 offset:41600
    v_max3_u32 v165, v32, v33, v165
    v_mfma_f32_16x16x32_bf16 v[56:59], v[124:127], v[32:35], v[56:59]
    ds_read_b64_tr_b16 v[124:125], v146 offset:40352
    ds_read_b64_tr_b16 v[126:127], v146 offset:41632
    v_max3_u32 v165, v34, v35, v165
    v_mfma_f32_16x16x32_bf16 v[60:63], v[128:131], v[32:35], v[60:63]
    ds_read_b64_tr_b16 v[128:129], v146 offset:40384
    ds_read_b64_tr_b16 v[130:131], v146 offset:41664
    v_mfma_f32_16x16x32_bf16 v[64:67], v[132:135], v[32:35], v[64:67]
    ds_read_b64_tr_b16 v[132:133], v146 offset:40416
    ds_read_b64_tr_b16 v[134:135], v146 offset:41696
    v_mfma_f32_16x16x32_bf16 v[68:71], v[136:139], v[32:35], v[68:71]
    ds_read_b64_tr_b16 v[136:137], v146 offset:40448
    ds_read_b64_tr_b16 v[138:139], v146 offset:41728
    s_waitcnt vmcnt(2) lgkmcnt(14)
    v_mfma_f32_16x16x32_bf16 v[52:55], v[80:83], v[36:39], v[52:55]
    v_max3_u32 v165, v36, v37, v165
    v_mfma_f32_16x16x32_bf16 v[56:59], v[84:87], v[36:39], v[56:59]
    v_max3_u32 v165, v38, v39, v165
    v_mfma_f32_16x16x32_bf16 v[60:63], v[88:91], v[36:39], v[60:63]
    v_mfma_f32_16x16x32_bf16 v[64:67], v[92:95], v[36:39], v[64:67]
    v_mfma_f32_16x16x32_bf16 v[68:71], v[96:99], v[36:39], v[68:71]
    s_waitcnt vmcnt(1) lgkmcnt(10)
    v_mfma_f32_16x16x32_bf16 v[52:55], v[100:103], v[40:43], v[52:55]
    v_max3_u32 v165, v40, v41, v165
    v_mfma_f32_16x16x32_bf16 v[56:59], v[104:107], v[40:43], v[56:59]
    v_max3_u32 v165, v42, v43, v165
    v_mfma_f32_16x16x32_bf16 v[60:63], v[108:111], v[40:43], v[60:63]
    v_mfma_f32_16x16x32_bf16 v[64:67], v[112:115], v[40:43], v[64:67]
    v_mfma_f32_16x16x32_bf16 v[68:71], v[116:119], v[40:43], v[68:71]
    s_waitcnt vmcnt(0) lgkmcnt(0)
    v_mfma_f32_16x16x32_bf16 v[52:55], v[120:123], v[44:47], v[52:55]
    v_max3_u32 v165, v44, v45, v165
    v_mfma_f32_16x16x32_bf16 v[56:59], v[124:127], v[44:47], v[56:59]
    v_max3_u32 v165, v46, v47, v165
    v_mfma_f32_16x16x32_bf16 v[60:63], v[128:131], v[44:47], v[60:63]
    v_cmp_eq_u32 vcc, -1, v165
    v_mfma_f32_16x16x32_bf16 v[64:67], v[132:135], v[44:47], v[64:67]
    v_mfma_f32_16x16x32_bf16 v[68:71], v[136:139], v[44:47], v[68:71]
    s_cbranch_vccnz L_oredo
L_odone:
    s_nop 2
    ds_write_b128 v151, v[52:55] offset:0
    ds_write_b128 v151, v[56:59] offset:64
    ds_write_b128 v151, v[60:63] offset:128
    ds_write_b128 v151, v[64:67] offset:192
    s_mov_b32 exec_hi, 0
    ds_write_b128 v151, v[68:71] offset:256
    s_mov_b32 exec_hi, -1
L_final:
    v_sub_u32 v154, v153, v10
    v_mul_u32_u24 v154, 72, v154
    v_sub_u32 v154, v152, v154
    v_add_u32 v153, 40000, v154
    v_add_u32 v154, 39680, v154
    s_cmp_lg_u64 s[26:27], 0
    s_waitcnt lgkmcnt(0)
    s_barrier
    ds_read_b128 v[24:27], v152
    ds_read_b128 v[32:35], v152 offset:18432
    ds_read_b128 v[28:31], v152 offset:16
    ds_read_b128 v[36:39], v152 offset:18448
    s_cbranch_scc1 L_routed
L_mix:
    s_waitcnt lgkmcnt(2)
    v_pk_add_f32 v[24:25], v[24:25], v[32:33]
    v_pk_add_f32 v[26:27], v[26:27], v[34:35]
    v_pk_fma_f32 v[24:25], v[24:25], v[8:9], v[72:73] op_sel_hi:[1,0,1]
    v_pk_fma_f32 v[26:27], v[26:27], v[8:9], v[74:75] op_sel_hi:[1,0,1]
    v_cvt_pk_bf16_f32 v16, v24, v25
    v_cvt_pk_bf16_f32 v17, v26, v27
    s_waitcnt lgkmcnt(0)
    v_pk_add_f32 v[28:29], v[28:29], v[36:37]
    v_pk_add_f32 v[30:31], v[30:31], v[38:39]
    v_pk_fma_f32 v[28:29], v[28:29], v[8:9], v[76:77] op_sel_hi:[1,0,1]
    v_pk_fma_f32 v[30:31], v[30:31], v[8:9], v[78:79] op_sel_hi:[1,0,1]
    v_cvt_pk_bf16_f32 v18, v28, v29
    v_cvt_pk_bf16_f32 v19, v30, v31
    buffer_store_dwordx4 v[16:19], v7, s[8:11], 0 offen
L_end:
    s_endpgm
L_follow:
    s_movk_i32 s30, 32767
L_poll18:
    ds_read_b32 v106, v10 offset:32
    s_waitcnt lgkmcnt(0)
    v_cmp_eq_u32 vcc, -1, v106
    s_cbranch_vccz L_ok19
    s_sleep 1
    s_sub_u32 s30, s30, 1
    s_cmp_lg_u32 s30, 0
    s_cbranch_scc1 L_poll18
L_ok19:
    v_readfirstlane_b32 s15, v106
    s_nop 3
    s_branch L_stage1b
L_general1:
    v_lshrrev_b32 v107, 2, v126
    v_lshlrev_b32 v107, 10, v107
    v_and_b32 v105, 3, v1
    v_lshl_or_b32 v107, v105, 2, v107
    s_lshl_b32 s24, s4, 7
    s_add_u32 s24, s24, 19398656
    s_movk_i32 s30, 16384
L_poll21:
    buffer_load_dword v106, v107, s[16:19], s24 offen sc1
    buffer_load_dword v105, v115, s[16:19], 0 offen sc1
    s_waitcnt vmcnt(0)
    v_cmp_ne_u32 vcc, 1, v106
    s_cbranch_vccz L_ok22
    v_cmp_ne_u32 vcc, s7, v105
    s_cbranch_vccz L_stage1
    s_sleep 4
    s_sub_u32 s30, s30, 1
    s_cmp_lg_u32 s30, 0
    s_cbranch_scc1 L_poll21
L_ok22:
    s_sub_u32 s15, s15, 7340032
    s_branch L_stage1
L_att_wait:
    s_movk_i32 s30, 16384
L_poll24:
    ds_read_b32 v158, v157 offset:64
    s_waitcnt lgkmcnt(0)
    v_cmp_ge_u32 vcc, s14, v158
    s_cbranch_vccz L_ok25
    s_sleep 1
    s_sub_u32 s30, s30, 1
    s_cmp_lg_u32 s30, 0
    s_cbranch_scc1 L_poll24
L_ok25:
    s_branch L_att_back
L_att_wait2:
    s_movk_i32 s30, 16384
L_poll27:
    ds_read_b32 v158, v157 offset:64
    s_waitcnt lgkmcnt(0)
    v_cmp_ge_u32 vcc, s14, v158
    s_cbranch_vccz L_ok28
    s_sleep 1
    s_sub_u32 s30, s30, 1
    s_cmp_lg_u32 s30, 0
    s_cbranch_scc1 L_poll27
L_ok28:
    s_branch L_att_back2
L_retry0:
    s_movk_i32 s30, 16384
L_poll30:
    ds_read_b32 v158, v148
    ds_read_b64 v[50:51], v141 offset:2048
    ds_read_b128 v[12:15], v140
    ds_read_b128 v[52:55], v140 offset:1024
    s_waitcnt lgkmcnt(0)
    v_cmp_gt_u32 vcc, 1, v158
    s_cbranch_vccz L_ok31
    s_sub_u32 s30, s30, 1
    s_cmp_lg_u32 s30, 0
    s_cbranch_scc1 L_poll30
L_ok31:
    s_branch L_got0
L_retry1:
    s_movk_i32 s30, 16384
L_poll33:
    ds_read_b32 v158, v148
    ds_read_b64 v[80:81], v143 offset:2048
    ds_read_b128 v[72:75], v142
    ds_read_b128 v[76:79], v142 offset:1024
    s_waitcnt lgkmcnt(0)
    v_cmp_gt_u32 vcc, 2, v158
    s_cbranch_vccz L_ok34
    s_sub_u32 s30, s30, 1
    s_cmp_lg_u32 s30, 0
    s_cbranch_scc1 L_poll33
L_ok34:
    s_branch L_got1
L_bad0:
    ds_write_b32 v10, v6 offset:8
    s_branch L_nostore0
L_bad1:
    ds_write_b32 v10, v6 offset:8
    s_waitcnt lgkmcnt(0)
    s_branch L_nostore1
L_oredo:
    s_sub_u32 s54, s54, 1
    s_cmp_lg_u32 s54, 0
    s_cbranch_scc1 L_oproj
    s_branch L_odone
L_routed:
    v_cndmask_b32 v20, v154, v153, s[28:29]
    s_mov_b64 exec, s[26:27]
    ds_read_b128 v[72:75], v20
    ds_read_b128 v[76:79], v20 offset:16
    s_mov_b64 exec, -1
    s_waitcnt lgkmcnt(0)
    s_branch L_mix
L_fallback:
    s_waitcnt lgkmcnt(0)
    s_barrier
    s_barrier
    s_mul_i32 s24, s12, 9216
    s_add_u32 s24, s24, 129024
    v_subrev_u32 v2, s24, v2
    v_subrev_u32 v3, s24, v3
    v_mul_u32_u24 v162, 7, v5
    v_sub_u32 v4, v4, v162
    s_mov_b32 exec_lo, 0
    v_mov_b32 v24, v159
    s_mov_b32 exec_lo, -1
    v_mov_b32 v166, 0xff800000
    v_mov_b32 v167, 0xff800000
    s_mov_b32 s14, 0
L_fb_max:
    ds_read_b64_tr_b16 v[28:29], v2 offset:0
    ds_read_b64_tr_b16 v[30:31], v2 offset:128
    ds_read_b64_tr_b16 v[26:27], v3 offset:0
    s_waitcnt lgkmcnt(0)
    v_mfma_f32_32x32x16_bf16 v[72:87], v[28:31], v[16:19], 0
    v_mfma_f32_32x32x16_bf16 v[88:103], v[28:31], v[20:23], 0
    s_nop 9
    v_mfma_f32_32x32x4_2b_bf16 v[72:103], v[26:27], v[24:25], v[72:103] cbsz:1 abid:0
    s_nop 15
    s_nop 3
    v_max3_f32 v166, v72, v73, v166
    v_max3_f32 v167, v88, v89, v167
    v_max3_f32 v166, v74, v75, v166
    v_max3_f32 v167, v90, v91, v167
    v_max3_f32 v166, v76, v77, v166
    v_max3_f32 v167, v92, v93, v167
    v_max3_f32 v166, v78, v79, v166
    v_max3_f32 v167, v94, v95, v167
    v_max3_f32 v166, v80, v81, v166
    v_max3_f32 v167, v96, v97, v167
    v_max3_f32 v166, v82, v83, v166
    v_max3_f32 v167, v98, v99, v167
    v_max3_f32 v166, v84, v85, v166
    v_max3_f32 v167, v100, v101, v167
    v_max3_f32 v166, v86, v87, v166
    v_max3_f32 v167, v102, v103, v167
    ds_read_b64_tr_b16 v[28:29], v2 offset:2304
    ds_read_b64_tr_b16 v[30:31], v2 offset:2432
    s_waitcnt lgkmcnt(0)
    v_mfma_f32_32x32x16_bf16 v[72:87], v[28:31], v[16:19], 0
    v_mfma_f32_32x32x16_bf16 v[88:103], v[28:31], v[20:23], 0
    s_nop 9
    v_mfma_f32_32x32x4_2b_bf16 v[72:103], v[26:27], v[24:25], v[72:103] cbsz:1 abid:1
    s_nop 15
    s_nop 3
    v_max3_f32 v166, v72, v73, v166
    v_max3_f32 v167, v88, v89, v167
    v_max3_f32 v166, v74, v75, v166
    v_max3_f32 v167, v90, v91, v167
    v_max3_f32 v166, v76, v77, v166
    v_max3_f32 v167, v92, v93, v167
    v_max3_f32 v166, v78, v79, v166
    v_max3_f32 v167, v94, v95, v167
    v_max3_f32 v166, v80, v81, v166
    v_max3_f32 v167, v96, v97, v167
    v_max3_f32 v166, v82, v83, v166
    v_max3_f32 v167, v98, v99, v167
    v_max3_f32 v166, v84, v85, v166
    v_max3_f32 v167, v100, v101, v167
    v_max3_f32 v166, v86, v87, v166
    v_max3_f32 v167, v102, v103, v167
    v_add_u32 v2, 4608, v2
    v_add_u32 v3, 4608, v3
    s_add_u32 s14, s14, 1
    s_cmp_lt_u32 s14, 32
    s_cbranch_scc1 L_fb_max
    v_mov_b32 v162, v166
    v_mov_b32 v163, v167
    s_mul_i32 s24, s12, 9216
    s_sub_u32 s24, 147456, s24
    v_permlane32_swap_b32 v162, v166
    v_permlane32_swap_b32 v163, v167
    v_subrev_u32 v2, s24, v2
    v_subrev_u32 v3, s24, v3
    v_max_f32 v166, v162, v166
    v_max_f32 v167, v163, v167
    v_mov_b64 v[40:41], 0
    v_mov_b64 v[42:43], 0
    v_mov_b64 v[44:45], 0
    v_mov_b64 v[46:47], 0
    v_mov_b64 v[48:49], 0
    v_mov_b64 v[50:51], 0
    v_mov_b64 v[52:53], 0
    v_mov_b64 v[54:55], 0
    v_mov_b64 v[56:57], 0
    v_mov_b64 v[58:59], 0
    v_mov_b64 v[60:61], 0
    v_mov_b64 v[62:63], 0
    v_mov_b64 v[64:65], 0
    v_mov_b64 v[66:67], 0
    v_mov_b64 v[68:69], 0
    v_mov_b64 v[70:71], 0
    s_mov_b32 s14, 0
L_fb_pv:
    ds_read_b64_tr_b16 v[28:29], v2 offset:0
    ds_read_b64_tr_b16 v[30:31], v2 offset:128
    ds_read_b64_tr_b16 v[26:27], v3 offset:0
    ds_read_b128 v[32:35], v4 offset:0
    ds_read_b128 v[36:39], v4 offset:1152
    s_waitcnt lgkmcnt(0)
    v_mfma_f32_32x32x16_bf16 v[72:87], v[28:31], v[16:19], 0
    v_mfma_f32_32x32x16_bf16 v[88:103], v[28:31], v[20:23], 0
    s_nop 9
    v_mfma_f32_32x32x4_2b_bf16 v[72:103], v[26:27], v[24:25], v[72:103] cbsz:1 abid:0
    s_nop 15
    s_nop 3
    v_sub_f32 v72, v72, v166
    v_sub_f32 v73, v73, v166
    v_sub_f32 v74, v74, v166
    v_sub_f32 v75, v75, v166
    v_sub_f32 v76, v76, v166
    v_sub_f32 v77, v77, v166
    v_sub_f32 v78, v78, v166
    v_sub_f32 v79, v79, v166
    v_sub_f32 v80, v80, v166
    v_sub_f32 v81, v81, v166
    v_sub_f32 v82, v82, v166
    v_sub_f32 v83, v83, v166
    v_sub_f32 v84, v84, v166
    v_sub_f32 v85, v85, v166
    v_sub_f32 v86, v86, v166
    v_sub_f32 v87, v87, v166
    v_sub_f32 v88, v88, v167
    v_sub_f32 v89, v89, v167
    v_sub_f32 v90, v90, v167
    v_sub_f32 v91, v91, v167
    v_sub_f32 v92, v92, v167
    v_sub_f32 v93, v93, v167
    v_sub_f32 v94, v94, v167
    v_sub_f32 v95, v95, v167
    v_sub_f32 v96, v96, v167
    v_sub_f32 v97, v97, v167
    v_sub_f32 v98, v98, v167
    v_sub_f32 v99, v99, v167
    v_sub_f32 v100, v100, v167
    v_sub_f32 v101, v101, v167
    v_sub_f32 v102, v102, v167
    v_sub_f32 v103, v103, v167
    v_exp_f32 v72, v72
    v_exp_f32 v73, v73
    v_exp_f32 v74, v74
    v_exp_f32 v75, v75
    v_exp_f32 v76, v76
    v_exp_f32 v77, v77
    v_exp_f32 v78, v78
    v_exp_f32 v79, v79
    v_exp_f32 v80, v80
    v_exp_f32 v81, v81
    v_exp_f32 v82, v82
    v_exp_f32 v83, v83
    v_exp_f32 v84, v84
    v_exp_f32 v85, v85
    v_exp_f32 v86, v86
    v_exp_f32 v87, v87
    v_exp_f32 v88, v88
    v_exp_f32 v89, v89
    v_exp_f32 v90, v90
    v_exp_f32 v91, v91
    v_exp_f32 v92, v92
    v_exp_f32 v93, v93
    v_exp_f32 v94, v94
    v_exp_f32 v95, v95
    v_exp_f32 v96, v96
    v_exp_f32 v97, v97
    v_exp_f32 v98, v98
    v_exp_f32 v99, v99
    v_exp_f32 v100, v100
    v_exp_f32 v101, v101
    v_exp_f32 v102, v102
    v_exp_f32 v103, v103
    s_nop 1
    v_smfmac_f32_32x32x32_bf16 v[40:55], v[32:35], v[72:79], v6
    v_smfmac_f32_32x32x32_bf16 v[40:55], v[36:39], v[80:87], v6
    v_smfmac_f32_32x32x32_bf16 v[56:71], v[32:35], v[88:95], v6
    v_smfmac_f32_32x32x32_bf16 v[56:71], v[36:39], v[96:103], v6
    ds_read_b64_tr_b16 v[28:29], v2 offset:2304
    ds_read_b64_tr_b16 v[30:31], v2 offset:2432
    ds_read_b128 v[32:35], v4 offset:2304
    ds_read_b128 v[36:39], v4 offset:3456
    s_waitcnt lgkmcnt(0)
    v_mfma_f32_32x32x16_bf16 v[72:87], v[28:31], v[16:19], 0
    v_mfma_f32_32x32x16_bf16 v[88:103], v[28:31], v[20:23], 0
    s_nop 9
    v_mfma_f32_32x32x4_2b_bf16 v[72:103], v[26:27], v[24:25], v[72:103] cbsz:1 abid:1
    s_nop 15
    s_nop 3
    v_sub_f32 v72, v72, v166
    v_sub_f32 v73, v73, v166
    v_sub_f32 v74, v74, v166
    v_sub_f32 v75, v75, v166
    v_sub_f32 v76, v76, v166
    v_sub_f32 v77, v77, v166
    v_sub_f32 v78, v78, v166
    v_sub_f32 v79, v79, v166
    v_sub_f32 v80, v80, v166
    v_sub_f32 v81, v81, v166
    v_sub_f32 v82, v82, v166
    v_sub_f32 v83, v83, v166
    v_sub_f32 v84, v84, v166
    v_sub_f32 v85, v85, v166
    v_sub_f32 v86, v86, v166
    v_sub_f32 v87, v87, v166
    v_sub_f32 v88, v88, v167
    v_sub_f32 v89, v89, v167
    v_sub_f32 v90, v90, v167
    v_sub_f32 v91, v91, v167
    v_sub_f32 v92, v92, v167
    v_sub_f32 v93, v93, v167
    v_sub_f32 v94, v94, v167
    v_sub_f32 v95, v95, v167
    v_sub_f32 v96, v96, v167
    v_sub_f32 v97, v97, v167
    v_sub_f32 v98, v98, v167
    v_sub_f32 v99, v99, v167
    v_sub_f32 v100, v100, v167
    v_sub_f32 v101, v101, v167
    v_sub_f32 v102, v102, v167
    v_sub_f32 v103, v103, v167
    v_exp_f32 v72, v72
    v_exp_f32 v73, v73
    v_exp_f32 v74, v74
    v_exp_f32 v75, v75
    v_exp_f32 v76, v76
    v_exp_f32 v77, v77
    v_exp_f32 v78, v78
    v_exp_f32 v79, v79
    v_exp_f32 v80, v80
    v_exp_f32 v81, v81
    v_exp_f32 v82, v82
    v_exp_f32 v83, v83
    v_exp_f32 v84, v84
    v_exp_f32 v85, v85
    v_exp_f32 v86, v86
    v_exp_f32 v87, v87
    v_exp_f32 v88, v88
    v_exp_f32 v89, v89
    v_exp_f32 v90, v90
    v_exp_f32 v91, v91
    v_exp_f32 v92, v92
    v_exp_f32 v93, v93
    v_exp_f32 v94, v94
    v_exp_f32 v95, v95
    v_exp_f32 v96, v96
    v_exp_f32 v97, v97
    v_exp_f32 v98, v98
    v_exp_f32 v99, v99
    v_exp_f32 v100, v100
    v_exp_f32 v101, v101
    v_exp_f32 v102, v102
    v_exp_f32 v103, v103
    s_nop 1
    v_smfmac_f32_32x32x32_bf16 v[40:55], v[32:35], v[72:79], v6
    v_smfmac_f32_32x32x32_bf16 v[40:55], v[36:39], v[80:87], v6
    v_smfmac_f32_32x32x32_bf16 v[56:71], v[32:35], v[88:95], v6
    v_smfmac_f32_32x32x32_bf16 v[56:71], v[36:39], v[96:103], v6
    ds_read_b64_tr_b16 v[28:29], v2 offset:4608
    ds_read_b64_tr_b16 v[30:31], v2 offset:4736
    ds_read_b64_tr_b16 v[26:27], v3 offset:4608
    ds_read_b128 v[32:35], v4 offset:4608
    ds_read_b128 v[36:39], v4 offset:5760
    s_waitcnt lgkmcnt(0)
    v_mfma_f32_32x32x16_bf16 v[72:87], v[28:31], v[16:19], 0
    v_mfma_f32_32x32x16_bf16 v[88:103], v[28:31], v[20:23], 0
    s_nop 9
    v_mfma_f32_32x32x4_2b_bf16 v[72:103], v[26:27], v[24:25], v[72:103] cbsz:1 abid:0
    s_nop 15
    s_nop 3
    v_sub_f32 v72, v72, v166
    v_sub_f32 v73, v73, v166
    v_sub_f32 v74, v74, v166
    v_sub_f32 v75, v75, v166
    v_sub_f32 v76, v76, v166
    v_sub_f32 v77, v77, v166
    v_sub_f32 v78, v78, v166
    v_sub_f32 v79, v79, v166
    v_sub_f32 v80, v80, v166
    v_sub_f32 v81, v81, v166
    v_sub_f32 v82, v82, v166
    v_sub_f32 v83, v83, v166
    v_sub_f32 v84, v84, v166
    v_sub_f32 v85, v85, v166
    v_sub_f32 v86, v86, v166
    v_sub_f32 v87, v87, v166
    v_sub_f32 v88, v88, v167
    v_sub_f32 v89, v89, v167
    v_sub_f32 v90, v90, v167
    v_sub_f32 v91, v91, v167
    v_sub_f32 v92, v92, v167
    v_sub_f32 v93, v93, v167
    v_sub_f32 v94, v94, v167
    v_sub_f32 v95, v95, v167
    v_sub_f32 v96, v96, v167
    v_sub_f32 v97, v97, v167
    v_sub_f32 v98, v98, v167
    v_sub_f32 v99, v99, v167
    v_sub_f32 v100, v100, v167
    v_sub_f32 v101, v101, v167
    v_sub_f32 v102, v102, v167
    v_sub_f32 v103, v103, v167
    v_exp_f32 v72, v72
    v_exp_f32 v73, v73
    v_exp_f32 v74, v74
    v_exp_f32 v75, v75
    v_exp_f32 v76, v76
    v_exp_f32 v77, v77
    v_exp_f32 v78, v78
    v_exp_f32 v79, v79
    v_exp_f32 v80, v80
    v_exp_f32 v81, v81
    v_exp_f32 v82, v82
    v_exp_f32 v83, v83
    v_exp_f32 v84, v84
    v_exp_f32 v85, v85
    v_exp_f32 v86, v86
    v_exp_f32 v87, v87
    v_exp_f32 v88, v88
    v_exp_f32 v89, v89
    v_exp_f32 v90, v90
    v_exp_f32 v91, v91
    v_exp_f32 v92, v92
    v_exp_f32 v93, v93
    v_exp_f32 v94, v94
    v_exp_f32 v95, v95
    v_exp_f32 v96, v96
    v_exp_f32 v97, v97
    v_exp_f32 v98, v98
    v_exp_f32 v99, v99
    v_exp_f32 v100, v100
    v_exp_f32 v101, v101
    v_exp_f32 v102, v102
    v_exp_f32 v103, v103
    s_nop 1
    v_smfmac_f32_32x32x32_bf16 v[40:55], v[32:35], v[72:79], v6
    v_smfmac_f32_32x32x32_bf16 v[40:55], v[36:39], v[80:87], v6
    v_smfmac_f32_32x32x32_bf16 v[56:71], v[32:35], v[88:95], v6
    v_smfmac_f32_32x32x32_bf16 v[56:71], v[36:39], v[96:103], v6
    ds_read_b64_tr_b16 v[28:29], v2 offset:6912
    ds_read_b64_tr_b16 v[30:31], v2 offset:7040
    ds_read_b128 v[32:35], v4 offset:6912
    ds_read_b128 v[36:39], v4 offset:8064
    s_waitcnt lgkmcnt(0)
    v_mfma_f32_32x32x16_bf16 v[72:87], v[28:31], v[16:19], 0
    v_mfma_f32_32x32x16_bf16 v[88:103], v[28:31], v[20:23], 0
    s_nop 9
    v_mfma_f32_32x32x4_2b_bf16 v[72:103], v[26:27], v[24:25], v[72:103] cbsz:1 abid:1
    s_nop 15
    s_nop 3
    v_sub_f32 v72, v72, v166
    v_sub_f32 v73, v73, v166
    v_sub_f32 v74, v74, v166
    v_sub_f32 v75, v75, v166
    v_sub_f32 v76, v76, v166
    v_sub_f32 v77, v77, v166
    v_sub_f32 v78, v78, v166
    v_sub_f32 v79, v79, v166
    v_sub_f32 v80, v80, v166
    v_sub_f32 v81, v81, v166
    v_sub_f32 v82, v82, v166
    v_sub_f32 v83, v83, v166
    v_sub_f32 v84, v84, v166
    v_sub_f32 v85, v85, v166
    v_sub_f32 v86, v86, v166
    v_sub_f32 v87, v87, v166
    v_sub_f32 v88, v88, v167
    v_sub_f32 v89, v89, v167
    v_sub_f32 v90, v90, v167
    v_sub_f32 v91, v91, v167
    v_sub_f32 v92, v92, v167
    v_sub_f32 v93, v93, v167
    v_sub_f32 v94, v94, v167
    v_sub_f32 v95, v95, v167
    v_sub_f32 v96, v96, v167
    v_sub_f32 v97, v97, v167
    v_sub_f32 v98, v98, v167
    v_sub_f32 v99, v99, v167
    v_sub_f32 v100, v100, v167
    v_sub_f32 v101, v101, v167
    v_sub_f32 v102, v102, v167
    v_sub_f32 v103, v103, v167
    v_exp_f32 v72, v72
    v_exp_f32 v73, v73
    v_exp_f32 v74, v74
    v_exp_f32 v75, v75
    v_exp_f32 v76, v76
    v_exp_f32 v77, v77
    v_exp_f32 v78, v78
    v_exp_f32 v79, v79
    v_exp_f32 v80, v80
    v_exp_f32 v81, v81
    v_exp_f32 v82, v82
    v_exp_f32 v83, v83
    v_exp_f32 v84, v84
    v_exp_f32 v85, v85
    v_exp_f32 v86, v86
    v_exp_f32 v87, v87
    v_exp_f32 v88, v88
    v_exp_f32 v89, v89
    v_exp_f32 v90, v90
    v_exp_f32 v91, v91
    v_exp_f32 v92, v92
    v_exp_f32 v93, v93
    v_exp_f32 v94, v94
    v_exp_f32 v95, v95
    v_exp_f32 v96, v96
    v_exp_f32 v97, v97
    v_exp_f32 v98, v98
    v_exp_f32 v99, v99
    v_exp_f32 v100, v100
    v_exp_f32 v101, v101
    v_exp_f32 v102, v102
    v_exp_f32 v103, v103
    s_nop 1
    v_smfmac_f32_32x32x32_bf16 v[40:55], v[32:35], v[72:79], v6
    v_smfmac_f32_32x32x32_bf16 v[40:55], v[36:39], v[80:87], v6
    v_smfmac_f32_32x32x32_bf16 v[56:71], v[32:35], v[88:95], v6
    v_smfmac_f32_32x32x32_bf16 v[56:71], v[36:39], v[96:103], v6
    v_add_u32 v2, 18432, v2
    v_add_u32 v3, 18432, v3
    v_add_u32 v4, v5, v4
    s_add_u32 s14, s14, 1
    s_cmp_lt_u32 s14, 8
    s_cbranch_scc1 L_fb_pv
    s_mov_b32 s61, -1
    s_nop 7
    s_cmp_lg_u32 s12, 0
    s_barrier
    s_cbranch_scc1 L_fb_second
    ds_write_b128 v140, v[40:43]
    ds_write_b128 v140, v[44:47] offset:1024
    ds_write_b64 v141, v[48:49] offset:2048
    ds_add_u32 v156, v11 offset:64
    ds_write_b128 v142, v[56:59]
    ds_write_b128 v142, v[60:63] offset:1024
    ds_write_b64 v143, v[64:65] offset:2048
    ds_add_u32 v156, v11 offset:64
    s_waitcnt lgkmcnt(0)
    s_branch L_stored
L_fb_second:
    ds_read_b32 v158, v148
    ds_read_b64 v[80:81], v141 offset:2048
    ds_read_b128 v[72:75], v140
    ds_read_b128 v[76:79], v140 offset:1024
    s_movk_i32 s30, 16384
    s_branch L_chk39
L_poll37:
    ds_read_b32 v158, v148
    ds_read_b64 v[80:81], v141 offset:2048
    ds_read_b128 v[72:75], v140
    ds_read_b128 v[76:79], v140 offset:1024
L_chk39:
    s_waitcnt lgkmcnt(0)
    v_cmp_gt_u32 vcc, 4, v158
    s_cbranch_vccz L_ok38
    s_sub_u32 s30, s30, 1
    s_cmp_lg_u32 s30, 0
    s_cbranch_scc1 L_poll37
L_ok38:
    v_add_f32 v49, v81, v49
    v_add_f32 v48, v80, v48
    v_rcp_f32 v80, v49
    v_subrev_u32 v158, 729808896, v49
    v_mul_f32 v48, v48, v80
    v_mov_b32 v49, v48
    v_cmp_lt_u32 vcc, 671088640, v158
    v_pk_add_f32 v[40:41], v[72:73], v[40:41]
    v_pk_add_f32 v[42:43], v[74:75], v[42:43]
    v_pk_add_f32 v[44:45], v[76:77], v[44:45]
    v_pk_add_f32 v[46:47], v[78:79], v[46:47]
    v_permlane32_swap_b32 v48, v49
    v_pk_mul_f32 v[40:41], v[40:41], v[80:81] op_sel_hi:[1,0]
    v_pk_mul_f32 v[42:43], v[42:43], v[80:81] op_sel_hi:[1,0]
    v_pk_mul_f32 v[44:45], v[44:45], v[80:81] op_sel_hi:[1,0]
    v_pk_mul_f32 v[46:47], v[46:47], v[80:81] op_sel_hi:[1,0]
    v_cvt_pk_bf16_f32 v40, v40, v41
    v_cvt_pk_bf16_f32 v41, v42, v43
    v_cvt_pk_bf16_f32 v42, v44, v45
    v_cvt_pk_bf16_f32 v43, v46, v47
    v_cvt_pk_bf16_f32 v44, v48, v49
    v_min_u32 v40, -2, v40
    v_min_u32 v41, -2, v41
    v_min_u32 v42, -2, v42
    v_min_u32 v43, -2, v43
    v_min_u32 v44, -2, v44
    buffer_store_dwordx4 v[40:43], v144, s[16:19], s52 offen sc1
    buffer_store_dword v44, v145, s[16:19], s53 offen sc1
    ds_read_b32 v158, v148
    ds_read_b64 v[80:81], v143 offset:2048
    ds_read_b128 v[72:75], v142
    ds_read_b128 v[76:79], v142 offset:1024
    s_movk_i32 s30, 16384
    s_branch L_chk43
L_poll41:
    ds_read_b32 v158, v148
    ds_read_b64 v[80:81], v143 offset:2048
    ds_read_b128 v[72:75], v142
    ds_read_b128 v[76:79], v142 offset:1024
L_chk43:
    s_waitcnt lgkmcnt(0)
    v_cmp_gt_u32 vcc, 4, v158
    s_cbranch_vccz L_ok42
    s_sub_u32 s30, s30, 1
    s_cmp_lg_u32 s30, 0
    s_cbranch_scc1 L_poll41
L_ok42:
    v_add_f32 v65, v81, v65
    v_add_f32 v64, v80, v64
    v_rcp_f32 v80, v65
    v_subrev_u32 v158, 729808896, v65
    v_mul_f32 v64, v64, v80
    v_mov_b32 v65, v64
    v_cmp_lt_u32 vcc, 671088640, v158
    v_pk_add_f32 v[56:57], v[72:73], v[56:57]
    v_pk_add_f32 v[58:59], v[74:75], v[58:59]
    v_pk_add_f32 v[60:61], v[76:77], v[60:61]
    v_pk_add_f32 v[62:63], v[78:79], v[62:63]
    v_permlane32_swap_b32 v64, v65
    v_pk_mul_f32 v[56:57], v[56:57], v[80:81] op_sel_hi:[1,0]
    v_pk_mul_f32 v[58:59], v[58:59], v[80:81] op_sel_hi:[1,0]
    v_pk_mul_f32 v[60:61], v[60:61], v[80:81] op_sel_hi:[1,0]
    v_pk_mul_f32 v[62:63], v[62:63], v[80:81] op_sel_hi:[1,0]
    v_cvt_pk_bf16_f32 v56, v56, v57
    v_cvt_pk_bf16_f32 v57, v58, v59
    v_cvt_pk_bf16_f32 v58, v60, v61
    v_cvt_pk_bf16_f32 v59, v62, v63
    v_cvt_pk_bf16_f32 v60, v64, v65
    v_min_u32 v56, -2, v56
    v_min_u32 v57, -2, v57
    v_min_u32 v58, -2, v58
    v_min_u32 v59, -2, v59
    v_min_u32 v60, -2, v60
    s_add_u32 s24, s52, 32768
    s_add_u32 s25, s53, 4096
    buffer_store_dwordx4 v[56:59], v144, s[16:19], s24 offen sc1
    buffer_store_dword v60, v145, s[16:19], s25 offen sc1
    s_branch L_stored
L_service:
    s_waitcnt lgkmcnt(0)
    s_sub_u32 s12, s3, 8
    s_lshl_b32 s62, s2, 7
    s_lshl2_add_u32 s62, s12, s62
    s_add_u32 s62, s62, 19398656
    s_lshr_b32 s13, s12, 1
    s_and_b32 s14, s12, 1
    s_lshr_b32 s59, s5, 3
    s_mov_b32 s54, 663552
    s_mov_b32 s55, 0x00020000
    s_cmp_lg_u32 s12, 0
    s_cbranch_scc1 L_noinit
    v_lshlrev_b32 v8, 2, v1
    v_lshrrev_b32 v9, 3, v1
    v_cmp_eq_u32 vcc, 2, v9
    v_add_u32 v8, 156672, v8
    s_nop 0
    v_cndmask_b32 v9, 0, v9, vcc
    v_writelane_b32 v9, -1, 8
    ds_write_b32 v8, v9
    s_waitcnt lgkmcnt(0)
L_noinit:
    s_mov_b32 s52, s36
    s_mov_b32 s53, s37
    s_getreg_b32 s24, hwreg(HW_REG_XCC_ID)
    s_and_b32 s24, s24, 15
    s_add_u32 s7, s24, 1
    s_and_b32 s24, s4, 1
    s_lshr_b32 s25, s4, 1
    s_lshl2_add_u32 s6, s24, s25
    s_lshr_b32 s38, s5, 3
    s_lshl2_add_u32 s38, s24, s38
    s_and_b32 s39, s5, 7
    s_lshl3_add_u32 s39, s25, s39
    s_cmp_eq_u32 s59, 2
    s_cselect_b32 s27, 1, 0
    s_movk_i32 s25, 1152
    s_cmp_eq_u32 s59, 0
    s_cselect_b32 s25, 576, s25
    s_cselect_b32 s26, 18432, 0
    s_mov_b32 s28, 27648
    v_and_b32 v15, 15, v1
    v_bfe_u32 v13, v1, 4, 1
    v_lshrrev_b32 v16, 5, v1
    v_mul_u32_u24 v16, s25, v16
    s_lshl_b32 s24, s14, 6
    v_add3_u32 v3, v15, s24, 0
    v_mul_u32_u24 v12, 3641, v3
    v_lshrrev_b32 v12, 16, v12
    v_mul_u32_u24 v14, 18, v12
    v_sub_u32 v3, v3, v14
    v_lshrrev_b32 v14, 4, v3
    v_bitop3_b32 v14, v14, s27, v13 bitop3:0x6a
    v_lshl_add_u32 v14, v14, 4, v16
    v_lshl_add_u32 v3, v3, 5, v14
    v_mad_u32_u24 v23, v12, s28, v3
    v_add3_u32 v3, v15, s24, 16
    v_mul_u32_u24 v12, 3641, v3
    v_lshrrev_b32 v12, 16, v12
    v_mul_u32_u24 v14, 18, v12
    v_sub_u32 v3, v3, v14
    v_lshrrev_b32 v14, 4, v3
    v_bitop3_b32 v14, v14, s27, v13 bitop3:0x6a
    v_lshl_add_u32 v14, v14, 4, v16
    v_lshl_add_u32 v3, v3, 5, v14
    v_mad_u32_u24 v24, v12, s28, v3
    v_add3_u32 v3, v15, s24, 32
    v_mul_u32_u24 v12, 3641, v3
    v_lshrrev_b32 v12, 16, v12
    v_mul_u32_u24 v14, 18, v12
    v_sub_u32 v3, v3, v14
    v_lshrrev_b32 v14, 4, v3
    v_bitop3_b32 v14, v14, s27, v13 bitop3:0x6a
    v_lshl_add_u32 v14, v14, 4, v16
    v_lshl_add_u32 v3, v3, 5, v14
    v_mad_u32_u24 v25, v12, s28, v3
    v_add3_u32 v3, v15, s24, 48
    v_mul_u32_u24 v12, 3641, v3
    v_lshrrev_b32 v12, 16, v12
    v_mul_u32_u24 v14, 18, v12
    v_sub_u32 v3, v3, v14
    v_lshrrev_b32 v14, 4, v3
    v_bitop3_b32 v14, v14, s27, v13 bitop3:0x6a
    v_lshl_add_u32 v14, v14, 4, v16
    v_lshl_add_u32 v3, v3, 5, v14
    v_mad_u32_u24 v26, v12, s28, v3
    v_add_u32 v3, 0x80, v15
    v_mul_u32_u24 v12, 3641, v3
    v_lshrrev_b32 v12, 16, v12
    v_mul_u32_u24 v14, 18, v12
    v_sub_u32 v3, v3, v14
    v_lshrrev_b32 v14, 4, v3
    v_bitop3_b32 v14, v14, s27, v13 bitop3:0x6a
    v_lshl_add_u32 v14, v14, 4, v16
    v_lshl_add_u32 v3, v3, 5, v14
    v_mad_u32_u24 v27, v12, s28, v3
    s_lshl_b32 s24, s4, 5
    s_add_u32 s24, s24, s5
    s_lshl2_add_u32 s24, s24, s12
    s_lshl_b32 s24, s24, 2
    s_add_u32 s61, s24, 19431424
    s_cmp_ge_u32 s5, 24
    s_cbranch_scc1 L_rg
    s_mul_i32 s27, s27, 576
    s_add_u32 s56, s26, s27
    s_and_b32 s24, s39, 24
    s_mul_i32 s24, s24, 27648
    s_add_u32 s56, s56, s24
    s_bfe_u32 s24, s5, 0x20001
    s_and_b32 s26, s38, 4
    s_add_u32 s24, s24, s26
    s_mul_i32 s24, s24, 884736
    s_add_u32 s56, s56, s24
    s_and_b32 s24, s5, 1
    s_lshl2_add_u32 s24, s24, s12
    s_xor_b32 s26, s24, 1
    s_mul_i32 s24, s24, s25
    s_mul_i32 s26, s26, s25
    s_lshl1_add_u32 s57, s26, s56
    s_lshl1_add_u32 s56, s24, s56
    s_add_u32 s58, s56, 7340032
    s_add_u32 s60, s57, 7340032
    s_cmp_eq_u32 s59, 0
    s_cselect_b32 s26, 0x3eae1a93, 1.0
    s_mov_b32 s27, s26
    v_bfe_u32 v3, v1, 2, 2
    v_and_b32 v12, 3, v1
    v_lshl_or_b32 v14, v3, 3, v12
    v_bfe_u32 v15, v1, 1, 3
    v_lshrrev_b32 v16, 4, v1
    v_xor_b32 v15, v15, v16
    v_lshlrev_b32 v15, 4, v15
    v_lshl_or_b32 v14, v14, 7, v15
    s_lshl_b32 s24, s12, 12
    v_add_u32 v6, s24, v14
    v_xor_b32 v7, 0x1000, v6
    v_xor_b32 v8, 64, v6
    v_xor_b32 v9, 64, v7
    v_mul_u32_u24 v13, 288, v3
    v_mul_u32_u24 v14, 2432, v16
    v_lshl_add_u32 v13, v12, 3, v13
    v_add_u32 v13, v13, v14
    v_add_u32 v11, 16640, v13
    s_lshl_b32 s24, s14, 7
    s_add_u32 s24, s24, 16384
    v_add_u32 v10, s24, v13
    v_mov_b64 v[16:17], v[6:7]
    v_mov_b64 v[18:19], v[8:9]
    v_mov_b64 v[20:21], v[10:11]
    s_mov_b32 s24, 0
    s_mov_b32 s25, 0
    v_mov_b64 v[44:45], 0
    v_mov_b64 v[46:47], 0
    v_mov_b64 v[48:49], 0
    v_mov_b64 v[50:51], 0
    v_mov_b64 v[52:53], 0
    v_mov_b64 v[54:55], 0
    v_mov_b64 v[56:57], 0
    v_mov_b64 v[58:59], 0
    v_mov_b64 v[76:77], 0
    v_mov_b64 v[78:79], 0
    v_mov_b64 v[80:81], 0
    v_mov_b64 v[82:83], 0
    v_mov_b64 v[84:85], 0
    v_mov_b64 v[86:87], 0
    v_mov_b64 v[88:89], 0
    v_mov_b64 v[90:91], 0
    v_mov_b64 v[92:93], 0
    v_mov_b64 v[94:95], 0
    v_mov_b64 v[96:97], 0
    v_mov_b64 v[98:99], 0
    v_mov_b64 v[100:101], 0
    v_mov_b64 v[102:103], 0
    v_mov_b64 v[104:105], 0
    v_mov_b64 v[106:107], 0
    v_mov_b64 v[108:109], 0
    v_mov_b64 v[110:111], 0
    v_mov_b64 v[112:113], 0
    v_mov_b64 v[114:115], 0
    v_mov_b64 v[116:117], 0
    v_mov_b64 v[118:119], 0
    v_mov_b64 v[120:121], 0
    v_mov_b64 v[122:123], 0
    v_mov_b64 v[124:125], 0
    v_mov_b64 v[126:127], 0
    v_mov_b64 v[128:129], 0
    v_mov_b64 v[130:131], 0
    v_mov_b64 v[132:133], 0
    v_mov_b64 v[134:135], 0
    v_mov_b64 v[136:137], 0
    v_mov_b64 v[138:139], 0
    v_mov_b64 v[140:141], 0
    v_mov_b64 v[142:143], 0
    v_mov_b64 v[144:145], 0
    v_mov_b64 v[146:147], 0
    v_mov_b64 v[148:149], 0
    v_mov_b64 v[150:151], 0
    v_mov_b64 v[152:153], 0
    v_mov_b64 v[154:155], 0
    v_mov_b64 v[156:157], 0
    v_mov_b64 v[158:159], 0
    v_mov_b64 v[160:161], 0
    v_mov_b64 v[162:163], 0
    v_mov_b64 v[164:165], 0
    v_mov_b64 v[166:167], 0
    v_and_b32 v3, 7, v1
    v_lshlrev_b32 v3, 5, v3
    s_setprio 3
.p2align 4
L_gemm:
    s_waitcnt lgkmcnt(10)
    v_mfma_f32_16x16x32_bf16 v[160:163], v[44:47], v[92:95], v[160:163]
    s_add_u32 s25, s25, 35840
    v_mfma_f32_16x16x32_bf16 v[164:167], v[48:51], v[92:95], v[164:167]
    s_cmp_eq_u32 s25, 143360
    s_cselect_b32 s25, 0, s25
    s_waitcnt lgkmcnt(6)
    v_mfma_f32_16x16x32_bf16 v[96:99], v[44:47], v[76:79], v[96:99]
    s_add_u32 s24, s24, 1
    v_mfma_f32_16x16x32_bf16 v[100:103], v[48:51], v[76:79], v[100:103]
    v_mfma_f32_16x16x32_bf16 v[104:107], v[52:55], v[76:79], v[104:107]
    v_mfma_f32_16x16x32_bf16 v[108:111], v[56:59], v[76:79], v[108:111]
    s_waitcnt lgkmcnt(0)
    s_barrier
    ds_read_b64_tr_b16 v[92:93], v21 offset:0
    v_mfma_f32_16x16x32_bf16 v[112:115], v[44:47], v[80:83], v[112:115]
    ds_read_b64_tr_b16 v[94:95], v21 offset:1152
    v_mfma_f32_16x16x32_bf16 v[116:119], v[48:51], v[80:83], v[116:119]
    ds_read_b128 v[28:31], v16 offset:0
    v_mfma_f32_16x16x32_bf16 v[120:123], v[52:55], v[80:83], v[120:123]
    ds_read_b128 v[32:35], v16 offset:512
    v_mfma_f32_16x16x32_bf16 v[124:127], v[56:59], v[80:83], v[124:127]
    ds_read_b128 v[36:39], v17 offset:0
    v_mfma_f32_16x16x32_bf16 v[128:131], v[44:47], v[84:87], v[128:131]
    ds_read_b128 v[40:43], v17 offset:512
    v_mfma_f32_16x16x32_bf16 v[132:135], v[48:51], v[84:87], v[132:135]
    ds_read_b64_tr_b16 v[76:77], v20 offset:0
    v_mfma_f32_16x16x32_bf16 v[136:139], v[52:55], v[84:87], v[136:139]
    ds_read_b64_tr_b16 v[78:79], v20 offset:1152
    v_mfma_f32_16x16x32_bf16 v[140:143], v[56:59], v[84:87], v[140:143]
    ds_read_b64_tr_b16 v[80:81], v20 offset:32
    v_mfma_f32_16x16x32_bf16 v[144:147], v[44:47], v[88:91], v[144:147]
    ds_read_b64_tr_b16 v[82:83], v20 offset:1184
    v_mfma_f32_16x16x32_bf16 v[148:151], v[48:51], v[88:91], v[148:151]
    ds_read_b64_tr_b16 v[84:85], v20 offset:64
    v_mfma_f32_16x16x32_bf16 v[152:155], v[52:55], v[88:91], v[152:155]
    ds_read_b64_tr_b16 v[86:87], v20 offset:1216
    v_mfma_f32_16x16x32_bf16 v[156:159], v[56:59], v[88:91], v[156:159]
    ds_read_b64_tr_b16 v[88:89], v20 offset:96
    s_waitcnt lgkmcnt(9)
    v_mfma_f32_16x16x32_bf16 v[160:163], v[28:31], v[92:95], v[160:163]
    ds_read_b64_tr_b16 v[90:91], v20 offset:1248
    v_mfma_f32_16x16x32_bf16 v[164:167], v[32:35], v[92:95], v[164:167]
    ds_read_b64_tr_b16 v[92:93], v21 offset:9728
    s_waitcnt lgkmcnt(7)
    v_mfma_f32_16x16x32_bf16 v[96:99], v[28:31], v[76:79], v[96:99]
    ds_read_b64_tr_b16 v[94:95], v21 offset:10880
    v_mfma_f32_16x16x32_bf16 v[100:103], v[32:35], v[76:79], v[100:103]
    ds_read_b128 v[44:47], v18 offset:0
    v_mfma_f32_16x16x32_bf16 v[104:107], v[36:39], v[76:79], v[104:107]
    ds_read_b128 v[48:51], v18 offset:512
    v_mfma_f32_16x16x32_bf16 v[108:111], v[40:43], v[76:79], v[108:111]
    ds_read_b128 v[52:55], v19 offset:0
    s_waitcnt lgkmcnt(9)
    v_mfma_f32_16x16x32_bf16 v[112:115], v[28:31], v[80:83], v[112:115]
    ds_read_b128 v[56:59], v19 offset:512
    v_mfma_f32_16x16x32_bf16 v[116:119], v[32:35], v[80:83], v[116:119]
    ds_read_b64_tr_b16 v[76:77], v20 offset:9728
    v_mfma_f32_16x16x32_bf16 v[120:123], v[36:39], v[80:83], v[120:123]
    ds_read_b64_tr_b16 v[78:79], v20 offset:10880
    v_mfma_f32_16x16x32_bf16 v[124:127], v[40:43], v[80:83], v[124:127]
    ds_read_b64_tr_b16 v[80:81], v20 offset:9760
    s_waitcnt lgkmcnt(11)
    v_mfma_f32_16x16x32_bf16 v[128:131], v[28:31], v[84:87], v[128:131]
    ds_read_b64_tr_b16 v[82:83], v20 offset:10912
    v_mfma_f32_16x16x32_bf16 v[132:135], v[32:35], v[84:87], v[132:135]
    v_add_u32 v16, s25, v6
    v_mfma_f32_16x16x32_bf16 v[136:139], v[36:39], v[84:87], v[136:139]
    v_add_u32 v17, s25, v7
    s_cmp_lt_u32 s24, 8
    v_mfma_f32_16x16x32_bf16 v[140:143], v[40:43], v[84:87], v[140:143]
    ds_read_b64_tr_b16 v[84:85], v20 offset:9792
    s_waitcnt lgkmcnt(11)
    v_mfma_f32_16x16x32_bf16 v[144:147], v[28:31], v[88:91], v[144:147]
    ds_read_b64_tr_b16 v[86:87], v20 offset:10944
    v_mfma_f32_16x16x32_bf16 v[148:151], v[32:35], v[88:91], v[148:151]
    v_add_u32 v18, s25, v8
    v_add_u32 v21, s25, v11
    v_mfma_f32_16x16x32_bf16 v[152:155], v[36:39], v[88:91], v[152:155]
    v_add_u32 v19, s25, v9
    v_mfma_f32_16x16x32_bf16 v[156:159], v[40:43], v[88:91], v[156:159]
    ds_read_b64_tr_b16 v[88:89], v20 offset:9824
    ds_read_b64_tr_b16 v[90:91], v20 offset:10976
    v_add_u32 v20, s25, v10
    s_cbranch_scc1 L_gemm
    buffer_load_dword v4, v3, s[20:23], 0 offen sc1
    s_waitcnt lgkmcnt(10)
    v_mfma_f32_16x16x32_bf16 v[160:163], v[44:47], v[92:95], v[160:163]
    v_mfma_f32_16x16x32_bf16 v[164:167], v[48:51], v[92:95], v[164:167]
    s_waitcnt lgkmcnt(6)
    v_mfma_f32_16x16x32_bf16 v[96:99], v[44:47], v[76:79], v[96:99]
    v_mfma_f32_16x16x32_bf16 v[100:103], v[48:51], v[76:79], v[100:103]
    v_mfma_f32_16x16x32_bf16 v[104:107], v[52:55], v[76:79], v[104:107]
    v_mfma_f32_16x16x32_bf16 v[108:111], v[56:59], v[76:79], v[108:111]
    s_waitcnt lgkmcnt(0)
    s_barrier
    ds_read_b64_tr_b16 v[92:93], v20 offset:0
    ds_read_b64_tr_b16 v[94:95], v20 offset:1152
    v_mfma_f32_16x16x32_bf16 v[112:115], v[44:47], v[80:83], v[112:115]
    ds_read_b128 v[28:31], v16 offset:0
    ds_read_b128 v[32:35], v16 offset:512
    v_mfma_f32_16x16x32_bf16 v[116:119], v[48:51], v[80:83], v[116:119]
    ds_read_b128 v[36:39], v17 offset:0
    ds_read_b128 v[40:43], v17 offset:512
    v_mfma_f32_16x16x32_bf16 v[120:123], v[52:55], v[80:83], v[120:123]
    ds_read_b64_tr_b16 v[76:77], v20 offset:9728
    ds_read_b64_tr_b16 v[78:79], v20 offset:10880
    v_mfma_f32_16x16x32_bf16 v[124:127], v[56:59], v[80:83], v[124:127]
    ds_read_b128 v[60:63], v18 offset:0
    ds_read_b128 v[64:67], v18 offset:512
    v_mfma_f32_16x16x32_bf16 v[128:131], v[44:47], v[84:87], v[128:131]
    ds_read_b128 v[68:71], v19 offset:0
    ds_read_b128 v[72:75], v19 offset:512
    v_mfma_f32_16x16x32_bf16 v[132:135], v[48:51], v[84:87], v[132:135]
    ds_read_b64_tr_b16 v[80:81], v20 offset:32
    ds_read_b64_tr_b16 v[82:83], v20 offset:1184
    v_mfma_f32_16x16x32_bf16 v[136:139], v[52:55], v[84:87], v[136:139]
    v_mfma_f32_16x16x32_bf16 v[140:143], v[56:59], v[84:87], v[140:143]
    ds_read_b64_tr_b16 v[84:85], v20 offset:9760
    ds_read_b64_tr_b16 v[86:87], v20 offset:10912
    v_mfma_f32_16x16x32_bf16 v[144:147], v[44:47], v[88:91], v[144:147]
    v_mfma_f32_16x16x32_bf16 v[148:151], v[48:51], v[88:91], v[148:151]
    v_mfma_f32_16x16x32_bf16 v[152:155], v[52:55], v[88:91], v[152:155]
    v_mfma_f32_16x16x32_bf16 v[156:159], v[56:59], v[88:91], v[156:159]
    ds_read_b64_tr_b16 v[88:89], v20 offset:64
    ds_read_b64_tr_b16 v[90:91], v20 offset:1216
    s_waitcnt lgkmcnt(14)
    v_mfma_f32_16x16x32_bf16 v[96:99], v[28:31], v[92:95], v[96:99]
    v_mfma_f32_16x16x32_bf16 v[100:103], v[32:35], v[92:95], v[100:103]
    s_waitcnt lgkmcnt(12)
    v_mfma_f32_16x16x32_bf16 v[104:107], v[36:39], v[92:95], v[104:107]
    v_mfma_f32_16x16x32_bf16 v[108:111], v[40:43], v[92:95], v[108:111]
    ds_read_b64_tr_b16 v[92:93], v20 offset:9792
    s_waitcnt lgkmcnt(9)
    v_mfma_f32_16x16x32_bf16 v[96:99], v[60:63], v[76:79], v[96:99]
    ds_read_b64_tr_b16 v[94:95], v20 offset:10944
    v_mfma_f32_16x16x32_bf16 v[100:103], v[64:67], v[76:79], v[100:103]
    s_waitcnt lgkmcnt(8)
    v_mfma_f32_16x16x32_bf16 v[104:107], v[68:71], v[76:79], v[104:107]
    v_mfma_f32_16x16x32_bf16 v[108:111], v[72:75], v[76:79], v[108:111]
    ds_read_b64_tr_b16 v[76:77], v20 offset:96
    s_waitcnt lgkmcnt(7)
    v_mfma_f32_16x16x32_bf16 v[112:115], v[28:31], v[80:83], v[112:115]
    s_nop 1
    ds_read_b64_tr_b16 v[78:79], v20 offset:1248
    v_mfma_f32_16x16x32_bf16 v[116:119], v[32:35], v[80:83], v[116:119]
    s_nop 1
    v_mfma_f32_16x16x32_bf16 v[120:123], v[36:39], v[80:83], v[120:123]
    v_mul_f32 v96, s26, v96
    v_mul_f32 v97, s26, v97
    v_mul_f32 v98, s26, v98
    v_mul_f32 v99, s26, v99
    v_mfma_f32_16x16x32_bf16 v[124:127], v[40:43], v[80:83], v[124:127]
    v_mul_f32 v100, s26, v100
    v_mul_f32 v101, s26, v101
    v_mul_f32 v102, s26, v102
    v_mul_f32 v103, s26, v103
    ds_read_b64_tr_b16 v[80:81], v20 offset:9824
    s_waitcnt lgkmcnt(7)
    v_mfma_f32_16x16x32_bf16 v[112:115], v[60:63], v[84:87], v[112:115]
    v_cvt_pk_bf16_f32 v96, v96, v97
    v_cvt_pk_bf16_f32 v97, v98, v99
    ds_read_b64_tr_b16 v[82:83], v20 offset:10976
    v_mfma_f32_16x16x32_bf16 v[116:119], v[64:67], v[84:87], v[116:119]
    v_cvt_pk_bf16_f32 v98, v100, v101
    v_cvt_pk_bf16_f32 v99, v102, v103
    buffer_store_dwordx4 v[96:99], v23, s[16:19], s58 offen
    v_mfma_f32_16x16x32_bf16 v[120:123], v[68:71], v[84:87], v[120:123]
    v_mul_f32 v104, s26, v104
    v_mul_f32 v105, s26, v105
    v_mul_f32 v106, s26, v106
    v_mul_f32 v107, s26, v107
    v_mfma_f32_16x16x32_bf16 v[124:127], v[72:75], v[84:87], v[124:127]
    v_mul_f32 v108, s26, v108
    v_mul_f32 v109, s26, v109
    v_mul_f32 v110, s26, v110
    v_mul_f32 v111, s26, v111
    ds_read_b64_tr_b16 v[84:85], v21 offset:0
    s_waitcnt lgkmcnt(7)
    v_mfma_f32_16x16x32_bf16 v[128:131], v[28:31], v[88:91], v[128:131]
    v_cvt_pk_bf16_f32 v104, v104, v105
    v_cvt_pk_bf16_f32 v105, v106, v107
    ds_read_b64_tr_b16 v[86:87], v21 offset:1152
    v_mfma_f32_16x16x32_bf16 v[132:135], v[32:35], v[88:91], v[132:135]
    v_cvt_pk_bf16_f32 v106, v108, v109
    v_cvt_pk_bf16_f32 v107, v110, v111
    buffer_store_dwordx4 v[104:107], v23, s[16:19], s60 offen
    v_mfma_f32_16x16x32_bf16 v[136:139], v[36:39], v[88:91], v[136:139]
    v_mul_f32 v112, s26, v112
    v_mul_f32 v113, s26, v113
    v_mul_f32 v114, s26, v114
    v_mul_f32 v115, s26, v115
    v_mfma_f32_16x16x32_bf16 v[140:143], v[40:43], v[88:91], v[140:143]
    v_mul_f32 v116, s26, v116
    v_mul_f32 v117, s26, v117
    v_mul_f32 v118, s26, v118
    v_mul_f32 v119, s26, v119
    ds_read_b64_tr_b16 v[88:89], v21 offset:9728
    s_waitcnt lgkmcnt(7)
    v_mfma_f32_16x16x32_bf16 v[128:131], v[60:63], v[92:95], v[128:131]
    v_cvt_pk_bf16_f32 v112, v112, v113
    v_cvt_pk_bf16_f32 v113, v114, v115
    ds_read_b64_tr_b16 v[90:91], v21 offset:10880
    v_mfma_f32_16x16x32_bf16 v[132:135], v[64:67], v[92:95], v[132:135]
    v_cvt_pk_bf16_f32 v114, v116, v117
    v_cvt_pk_bf16_f32 v115, v118, v119
    buffer_store_dwordx4 v[112:115], v24, s[16:19], s58 offen
    v_mfma_f32_16x16x32_bf16 v[136:139], v[68:71], v[92:95], v[136:139]
    v_mul_f32 v120, s26, v120
    v_mul_f32 v121, s26, v121
    v_mul_f32 v122, s26, v122
    v_mul_f32 v123, s26, v123
    v_mfma_f32_16x16x32_bf16 v[140:143], v[72:75], v[92:95], v[140:143]
    v_mul_f32 v124, s26, v124
    v_mul_f32 v125, s26, v125
    v_mul_f32 v126, s26, v126
    v_mul_f32 v127, s26, v127
    s_waitcnt lgkmcnt(6)
    v_mfma_f32_16x16x32_bf16 v[144:147], v[28:31], v[76:79], v[144:147]
    v_cvt_pk_bf16_f32 v120, v120, v121
    v_cvt_pk_bf16_f32 v121, v122, v123
    s_waitcnt lgkmcnt(0)
    s_barrier
    v_mfma_f32_16x16x32_bf16 v[148:151], v[32:35], v[76:79], v[148:151]
    v_cvt_pk_bf16_f32 v122, v124, v125
    v_cvt_pk_bf16_f32 v123, v126, v127
    buffer_store_dwordx4 v[120:123], v24, s[16:19], s60 offen
    v_mfma_f32_16x16x32_bf16 v[152:155], v[36:39], v[76:79], v[152:155]
    v_mul_f32 v128, s26, v128
    v_mul_f32 v129, s26, v129
    v_mul_f32 v130, s26, v130
    v_mul_f32 v131, s26, v131
    v_mfma_f32_16x16x32_bf16 v[156:159], v[40:43], v[76:79], v[156:159]
    v_mul_f32 v132, s26, v132
    v_mul_f32 v133, s26, v133
    v_mul_f32 v134, s26, v134
    v_mul_f32 v135, s26, v135
    v_mfma_f32_16x16x32_bf16 v[144:147], v[60:63], v[80:83], v[144:147]
    v_cvt_pk_bf16_f32 v128, v128, v129
    v_cvt_pk_bf16_f32 v129, v130, v131
    v_mfma_f32_16x16x32_bf16 v[148:151], v[64:67], v[80:83], v[148:151]
    v_cvt_pk_bf16_f32 v130, v132, v133
    v_cvt_pk_bf16_f32 v131, v134, v135
    buffer_store_dwordx4 v[128:131], v25, s[16:19], s58 offen
    v_mfma_f32_16x16x32_bf16 v[152:155], v[68:71], v[80:83], v[152:155]
    v_mul_f32 v136, s26, v136
    v_mul_f32 v137, s26, v137
    v_mul_f32 v138, s26, v138
    v_mul_f32 v139, s26, v139
    v_mfma_f32_16x16x32_bf16 v[156:159], v[72:75], v[80:83], v[156:159]
    v_mul_f32 v140, s26, v140
    v_mul_f32 v141, s26, v141
    v_mul_f32 v142, s26, v142
    v_mul_f32 v143, s26, v143
    v_mfma_f32_16x16x32_bf16 v[160:163], v[28:31], v[84:87], v[160:163]
    v_cvt_pk_bf16_f32 v136, v136, v137
    v_cvt_pk_bf16_f32 v137, v138, v139
    v_mfma_f32_16x16x32_bf16 v[164:167], v[32:35], v[84:87], v[164:167]
    v_cvt_pk_bf16_f32 v138, v140, v141
    v_cvt_pk_bf16_f32 v139, v142, v143
    buffer_store_dwordx4 v[136:139], v25, s[16:19], s60 offen
    v_mfma_f32_16x16x32_bf16 v[160:163], v[60:63], v[88:91], v[160:163]
    v_mul_f32 v144, s26, v144
    v_mul_f32 v145, s26, v145
    v_mul_f32 v146, s26, v146
    v_mul_f32 v147, s26, v147
    v_mfma_f32_16x16x32_bf16 v[164:167], v[64:67], v[88:91], v[164:167]
    v_mul_f32 v148, s26, v148
    v_mul_f32 v149, s26, v149
    v_mul_f32 v150, s26, v150
    v_mul_f32 v151, s26, v151
    v_cvt_pk_bf16_f32 v144, v144, v145
    v_cvt_pk_bf16_f32 v145, v146, v147
    v_cvt_pk_bf16_f32 v146, v148, v149
    v_cvt_pk_bf16_f32 v147, v150, v151
    buffer_store_dwordx4 v[144:147], v26, s[16:19], s58 offen
    v_pk_mul_f32 v[152:153], v[152:153], s[26:27]
    v_pk_mul_f32 v[154:155], v[154:155], s[26:27]
    v_pk_mul_f32 v[156:157], v[156:157], s[26:27]
    v_pk_mul_f32 v[158:159], v[158:159], s[26:27]
    v_cvt_pk_bf16_f32 v152, v152, v153
    v_cvt_pk_bf16_f32 v153, v154, v155
    v_cvt_pk_bf16_f32 v154, v156, v157
    v_cvt_pk_bf16_f32 v155, v158, v159
    buffer_store_dwordx4 v[152:155], v26, s[16:19], s60 offen
    v_pk_mul_f32 v[160:161], v[160:161], s[26:27]
    v_pk_mul_f32 v[162:163], v[162:163], s[26:27]
    v_pk_mul_f32 v[164:165], v[164:165], s[26:27]
    v_pk_mul_f32 v[166:167], v[166:167], s[26:27]
    v_cvt_pk_bf16_f32 v160, v160, v161
    v_cvt_pk_bf16_f32 v161, v162, v163
    v_cvt_pk_bf16_f32 v162, v164, v165
    v_cvt_pk_bf16_f32 v163, v166, v167
    buffer_store_dwordx4 v[160:163], v27, s[16:19], s58 offen
    v_mov_b32 v6, s7
    v_mov_b32 v5, 0
    s_movk_i32 s30, 16384
    s_branch L_chk46
L_poll44:
    buffer_load_dword v4, v3, s[20:23], 0 offen sc1
L_chk46:
    s_waitcnt vmcnt(0)
    v_cmp_eq_u32 vcc, 0, v4
    s_cbranch_vccz L_ok45
    s_sub_u32 s30, s30, 1
    s_cmp_lg_u32 s30, 0
    s_cbranch_scc1 L_poll44
L_ok45:
L_svc:
    s_mov_b64 exec, 1
    buffer_store_dword v6, v5, s[16:19], s61 offen
    s_mov_b64 exec, -1
    s_setprio 3
    s_and_b32 s15, s5, 3
    s_lshl2_add_u32 s15, s6, s15
    s_lshl_b32 s15, s15, 6
    s_mov_b32 s61, 0
    v_mov_b32 v10, 156672
    v_mov_b32 v11, 1
    v_lshlrev_b32 v2, 4, v1
    s_cmp_lg_u32 s12, 0
    s_cbranch_scc1 L_helper
    v_add_u32 v3, 0, v1
    v_mul_u32_u24 v4, 6554, v3
    v_lshrrev_b32 v4, 16, v4
    v_mul_u32_u24 v9, 10, v4
    v_sub_u32 v3, v3, v9
    v_mul_u32_u24 v4, 1152, v4
    v_lshl_add_u32 v4, v3, 4, v4
    v_add_u32 v3, 7, v3
    v_and_b32 v3, 16, v3
    v_lshl_add_u32 v16, v3, 20, v4
    v_add_u32 v3, 64, v1
    v_mul_u32_u24 v4, 6554, v3
    v_lshrrev_b32 v4, 16, v4
    v_mul_u32_u24 v9, 10, v4
    v_sub_u32 v3, v3, v9
    v_mul_u32_u24 v4, 1152, v4
    v_lshl_add_u32 v4, v3, 4, v4
    v_add_u32 v3, 7, v3
    v_and_b32 v3, 16, v3
    v_lshl_add_u32 v17, v3, 20, v4
    v_subrev_u32 v17, 1024, v17
    v_add_u32 v3, 128, v1
    v_mul_u32_u24 v4, 6554, v3
    v_lshrrev_b32 v4, 16, v4
    v_mul_u32_u24 v9, 10, v4
    v_sub_u32 v3, v3, v9
    v_mul_u32_u24 v4, 1152, v4
    v_lshl_add_u32 v4, v3, 4, v4
    v_add_u32 v3, 7, v3
    v_and_b32 v3, 16, v3
    v_lshl_add_u32 v18, v3, 20, v4
    v_subrev_u32 v18, 2048, v18
    v_add_u32 v3, 192, v1
    v_mul_u32_u24 v4, 6554, v3
    v_lshrrev_b32 v4, 16, v4
    v_mul_u32_u24 v9, 10, v4
    v_sub_u32 v3, v3, v9
    v_mul_u32_u24 v4, 1152, v4
    v_lshl_add_u32 v4, v3, 4, v4
    v_add_u32 v3, 7, v3
    v_and_b32 v3, 16, v3
    v_lshl_add_u32 v19, v3, 20, v4
    v_subrev_u32 v19, 3072, v19
    v_add_u32 v3, 256, v1
    v_mul_u32_u24 v4, 6554, v3
    v_lshrrev_b32 v4, 16, v4
    v_mul_u32_u24 v9, 10, v4
    v_sub_u32 v3, v3, v9
    v_mul_u32_u24 v4, 1152, v4
    v_lshl_add_u32 v4, v3, 4, v4
    v_add_u32 v3, 7, v3
    v_and_b32 v3, 16, v3
    v_lshl_add_u32 v20, v3, 20, v4
    v_lshlrev_b32 v21, 3, v1
    v_lshrrev_b32 v3, 2, v1
    v_lshlrev_b32 v3, 10, v3
    v_and_b32 v4, 3, v1
    v_lshl_or_b32 v22, v4, 2, v3
    v_max_u32 v4, 1, v4
    v_bfe_u32 v3, v1, 2, 2
    v_lshlrev_b32 v3, 13, v3
    v_lshl_or_b32 v9, v4, 2, v3
    s_lshl_b32 s28, s4, 9
    s_add_u32 s28, s28, 19431424
    s_mul_i32 s13, s39, 27648
    s_add_u32 s25, s13, 7340032
    s_mov_b32 s26, 1
    s_mov_b32 s27, 27648
    s_movk_i32 s30, 128
L_poll47:
    ds_read_b32 v4, v10 offset:24
    s_waitcnt lgkmcnt(0)
    v_cmp_gt_u32 vcc, 1, v4
    s_cbranch_vccz L_ok48
    s_sleep 1
    s_sub_u32 s30, s30, 1
    s_cmp_lg_u32 s30, 0
    s_cbranch_scc1 L_poll47
L_ok48:
    s_movk_i32 s30, 48
L_poll50:
    buffer_load_dwordx2 v[12:13], v21, s[16:19], s28 offen sc1
    s_waitcnt vmcnt(0)
    v_xor_b32 v12, s7, v12
    v_xor_b32 v13, s7, v13
    v_or_b32 v12, v12, v13
    v_cmp_ne_u32 vcc, 0, v12
    s_cbranch_vccz L_ok51
    s_sleep 2
    s_sub_u32 s30, s30, 1
    s_cmp_lg_u32 s30, 0
    s_cbranch_scc1 L_poll50
L_ok51:
    s_cbranch_vccnz L_general2
    ds_write_b32 v10, v11 offset:12
L_stage2:
    s_movk_i32 s29, 3
    s_call_b64 s[0:1], L_slots
    s_mov_b64 exec, 1
    ds_add_u32 v10, v11 offset:28
    s_mov_b64 exec, -1
    s_waitcnt vmcnt(36)
    s_mov_b64 exec, 1
    ds_add_u32 v10, v11 offset:96
    s_mov_b64 exec, -1
    s_waitcnt vmcnt(0)
    s_mov_b64 exec, 3
    ds_add_u32 v10, v11 offset:96
    s_mov_b64 exec, -1
    s_and_b32 s28, s5, 7
    s_lshl_b32 s28, s28, 3
    s_xor_b32 s24, s4, 1
    s_add_u32 s28, s28, s24
    s_lshl_b32 s28, s28, 7
    s_add_u32 s28, s28, 19398688
    s_mov_b64 exec, 0xffff
    s_movk_i32 s30, 16384
L_poll53:
    buffer_load_dword v4, v9, s[16:19], s28 offen sc1
    s_waitcnt vmcnt(0)
    v_cmp_ne_u32 vcc, 1, v4
    s_cbranch_vccz L_ok54
    s_sleep 4
    s_sub_u32 s30, s30, 1
    s_cmp_lg_u32 s30, 0
    s_cbranch_scc1 L_poll53
L_ok54:
    s_mov_b64 exec, -1
    s_mov_b32 s25, s13
    s_movk_i32 s29, 3
    s_call_b64 s[0:1], L_slots
    v_mul_u32_u24 v3, 7282, v0
    v_lshrrev_b32 v3, 16, v3
    v_mul_u32_u24 v4, 9, v3
    v_sub_u32 v4, v0, v4
    s_and_b32 s24, s5, 3
    s_lshl2_add_u32 s24, s6, s24
    s_lshl_b32 s24, s24, 6
    s_lshr_b32 s25, s5, 2
    s_mul_i32 s25, s25, 144
    v_lshl_add_u32 v153, v3, 2, v10
    v_add_u32 v3, s24, v3
    v_sub_u32 v154, 2047, v3
    v_mul_u32_u24 v7, 1152, v3
    v_lshl_add_u32 v7, v4, 4, v7
    v_add_u32 v7, s25, v7
    v_lshlrev_b32 v152, 5, v0
    v_add_u32 v152, 119808, v152
    v_and_b32 v157, 7, v1
    v_lshl_add_u32 v157, v157, 2, v10
    s_mov_b32 s25, s13
    s_movk_i32 s30, 16384
L_poll56:
    ds_read_b32 v158, v157 offset:64
    s_waitcnt lgkmcnt(0)
    v_cmp_gt_u32 vcc, 3, v158
    s_cbranch_vccz L_ok57
    s_sleep 4
    s_sub_u32 s30, s30, 1
    s_cmp_lg_u32 s30, 0
    s_cbranch_scc1 L_poll56
L_ok57:
    s_movk_i32 s29, 1
    s_call_b64 s[0:1], L_slots
    buffer_load_dwordx4 v[12:15], v7, s[8:11], 0 offen
    s_mov_b64 exec, 1
    ds_add_u32 v10, v11 offset:28
    s_mov_b64 exec, -1
    s_mov_b64 exec, 1
    ds_add_u32 v10, v11 offset:96
    s_mov_b64 exec, -1
    s_movk_i32 s30, 16384
L_poll59:
    ds_read_b32 v4, v10 offset:36
    s_waitcnt lgkmcnt(0)
    v_cmp_ne_u32 vcc, 3, v4
    s_cbranch_vccz L_ok60
    s_sleep 8
    s_sub_u32 s30, s30, 1
    s_cmp_lg_u32 s30, 0
    s_cbranch_scc1 L_poll59
L_ok60:
    s_movk_i32 s30, 16384
L_poll62:
    ds_read_b32 v158, v157 offset:64
    s_waitcnt lgkmcnt(0)
    v_cmp_gt_u32 vcc, 4, v158
    s_cbranch_vccz L_ok63
    s_sleep 8
    s_sub_u32 s30, s30, 1
    s_cmp_lg_u32 s30, 0
    s_cbranch_scc1 L_poll62
L_ok63:
    s_mov_b64 exec, 1
    ds_add_u32 v10, v11 offset:28
    s_mov_b64 exec, -1
    v_and_b32 v21, 7, v1
    v_bfe_u32 v4, v1, 3, 2
    v_lshlrev_b32 v4, 8, v4
    v_lshl_or_b32 v21, v21, 10, v4
    s_lshr_b32 s28, s4, 1
    s_lshl_b32 s28, s28, 6
    s_and_b32 s24, s4, 1
    s_add_u32 s28, s28, s24
    s_lshl_b32 s28, s28, 7
    s_add_u32 s28, s28, 19398688
    s_waitcnt vmcnt(0)
    s_mov_b64 exec, 15
    ds_add_u32 v10, v11 offset:96
    s_mov_b64 exec, -1
    s_mov_b32 exec_hi, 0
    s_movk_i32 s30, 16384
L_poll65:
    buffer_load_dwordx4 v[24:27], v21, s[16:19], s28 offen sc1
    s_waitcnt vmcnt(0)
    v_bitop3_b32 v4, v25, v26, v27 bitop3:0x80
    v_cmp_ne_u32 vcc, 1, v4
    s_cbranch_vccz L_ok66
    s_sleep 8
    s_sub_u32 s30, s30, 1
    s_cmp_lg_u32 s30, 0
    s_cbranch_scc1 L_poll65
L_ok66:
    s_mov_b32 exec_hi, -1
    s_movk_i32 s30, 16384
L_poll68:
    ds_read_b32 v158, v157 offset:64
    s_waitcnt lgkmcnt(0)
    v_cmp_gt_u32 vcc, 7, v158
    s_cbranch_vccz L_ok69
    s_sleep 16
    s_sub_u32 s30, s30, 1
    s_cmp_lg_u32 s30, 0
    s_cbranch_scc1 L_poll68
L_ok69:
    s_cmp_lg_u32 s5, 20
    s_cbranch_scc1 L_wo
    s_getpc_b64 s[24:25]
L_pc71:
    s_sub_u32 s24, s24, L_pc71 - gated_mix__mha_block__moe_arch_mod__prompt_kernel
    s_subb_u32 s25, s25, 0
    v_min_u32 v3, (L_codeend - gated_mix__mha_block__moe_arch_mod__prompt_kernel - 4) / 128, v1
    v_lshlrev_b32 v3, 7, v3
    global_load_dword v35, v3, s[24:25]
L_wo:
    s_lshr_b32 s26, s5, 2
    s_mul_i32 s26, s26, 144
    s_add_u32 s24, s26, 294912
    s_mov_b32 s25, 50176
    s_mov_b32 s27, 101376
L_wo_loop:
    s_mov_b32 m0, s25
    s_setprio 0
    buffer_load_dwordx4 v16, s[52:55], s24 offen offset:0 lds
    buffer_load_dwordx4 v17, s[52:55], s24 offen offset:1024 lds
    buffer_load_dwordx4 v18, s[52:55], s24 offen offset:2048 lds
    buffer_load_dwordx4 v19, s[52:55], s24 offen offset:3072 lds
    s_add_u32 m0, s25, 4096
    s_add_u32 s25, s25, 5120
    buffer_load_dwordx4 v20, s[52:55], s24 offen lds
    s_add_u32 s24, s24, 36864
    s_cmp_lt_u32 s25, s27
    s_waitcnt vmcnt(10)
    s_cbranch_scc1 L_wo_loop
    s_setprio 3
    s_cmp_eq_u32 s27, 50176
    s_cbranch_scc1 L_wo_done
    s_add_u32 s24, s5, 10
    s_and_b32 s24, s24, 31
    s_cmp_lt_u32 s24, 18
    s_cselect_b32 s24, 6, 3
    s_movk_i32 s30, 16384
L_poll72:
    ds_read_b32 v4, v10 offset:36
    s_waitcnt lgkmcnt(0)
    v_cmp_ne_u32 vcc, s24, v4
    s_cbranch_vccz L_ok73
    s_sleep 8
    s_sub_u32 s30, s30, 1
    s_cmp_lg_u32 s30, 0
    s_cbranch_scc1 L_poll72
L_ok73:
    s_mov_b32 s24, s26
    s_mov_b32 s25, 9216
    s_mov_b32 s27, 50176
    s_branch L_wo_loop
L_wo_done:
    s_waitcnt vmcnt(0) lgkmcnt(0)
    s_barrier
    ds_read_b32 v4, v10 offset:8
    ds_read_b32 v8, v153 offset:6144
    ds_read_b64 v[162:163], v10 offset:16
    s_waitcnt lgkmcnt(0)
    v_cmp_lt_u32 vcc, s61, v4
    s_cbranch_vccnz L_w8_fb
    v_lshlrev_b32 v72, 16, v12
    v_and_b32 v73, 0xffff0000, v12
    v_lshlrev_b32 v74, 16, v13
    v_and_b32 v75, 0xffff0000, v13
    v_lshlrev_b32 v76, 16, v14
    v_and_b32 v77, 0xffff0000, v14
    v_lshlrev_b32 v78, 16, v15
    v_and_b32 v79, 0xffff0000, v15
    v_sub_f32 v160, 1.0, v8
    v_cvt_pk_bf16_f32 v160, v160, v160
    v_and_b32 v160, 0xffff0000, v160
    v_and_b32 v162, 0x7ff, v162
    v_and_b32 v163, 0x7ff, v163
    v_cmp_eq_u32 s[26:27], v162, v154
    v_cmp_eq_u32 s[28:29], v163, v154
    v_pk_mul_f32 v[72:73], v[72:73], v[160:161] op_sel_hi:[1,0]
    v_pk_mul_f32 v[74:75], v[74:75], v[160:161] op_sel_hi:[1,0]
    v_pk_mul_f32 v[76:77], v[76:77], v[160:161] op_sel_hi:[1,0]
    v_pk_mul_f32 v[78:79], v[78:79], v[160:161] op_sel_hi:[1,0]
    s_or_b64 s[26:27], s[26:27], s[28:29]
    s_mov_b32 s8, s50
    s_mov_b32 s9, s51
    s_branch L_final
L_w8_fb:
    s_barrier
    s_and_b32 s28, s5, 7
    s_lshl_b32 s28, s28, 3
    s_xor_b32 s24, s4, 0
    s_add_u32 s28, s28, s24
    s_lshl_b32 s28, s28, 7
    s_add_u32 s28, s28, 19398688
    s_mov_b64 exec, 0xffff
    s_movk_i32 s30, 16384
L_poll75:
    buffer_load_dword v4, v9, s[16:19], s28 offen sc1
    s_waitcnt vmcnt(0)
    v_cmp_ne_u32 vcc, 1, v4
    s_cbranch_vccz L_ok76
    s_sleep 4
    s_sub_u32 s30, s30, 1
    s_cmp_lg_u32 s30, 0
    s_cbranch_scc1 L_poll75
L_ok76:
    s_mov_b64 exec, -1
    s_mov_b32 s25, s13
    s_mov_b32 s26, 0
    s_mov_b32 s27, 9216
    s_movk_i32 s29, 8
    s_call_b64 s[0:1], L_slots
    s_waitcnt vmcnt(0)
    s_barrier
    s_mov_b32 s61, -1
    s_barrier
    s_branch L_wo
L_general2:
    v_mov_b32 v4, 2
    ds_write_b32 v10, v4 offset:12
    s_cmp_eq_u32 s59, 3
    s_cbranch_scc1 L_qok78
    s_movk_i32 s30, 16384
L_poll79:
    ds_read_b32 v4, v10 offset:12
    s_waitcnt lgkmcnt(0)
    v_cmp_eq_u32 vcc, 0, v4
    s_cbranch_vccz L_ok80
    s_sleep 4
    s_sub_u32 s30, s30, 1
    s_cmp_lg_u32 s30, 0
    s_cbranch_scc1 L_poll79
L_ok80:
    v_cmp_eq_u32 vcc, 1, v4
    s_cbranch_vccnz L_qok78
    s_call_b64 s[0:1], L_publish
L_qok78:
    s_lshl_b32 s29, s4, 7
    s_add_u32 s29, s29, 19406848
    s_movk_i32 s30, 16384
L_poll82:
    buffer_load_dwordx2 v[12:13], v21, s[16:19], s28 offen sc1
    buffer_load_dword v4, v22, s[16:19], s29 offen sc1
    s_waitcnt vmcnt(0)
    v_xor_b32 v12, s7, v12
    v_xor_b32 v13, s7, v13
    v_or_b32 v12, v12, v13
    v_cmp_ne_u32 vcc, 0, v12
    s_lshr_b64 vcc, vcc, 16
    s_lshl_b64 vcc, vcc, 32
    s_cbranch_vccz L_ok83
    v_cmp_ne_u32 vcc, 1, v4
    s_cbranch_vccz L_general3
    s_sleep 4
    s_sub_u32 s30, s30, 1
    s_cmp_lg_u32 s30, 0
    s_cbranch_scc1 L_poll82
L_ok83:
    s_branch L_stage2
L_general3:
    s_mov_b32 s25, s13
    s_branch L_stage2
L_publish:
    buffer_store_dwordx4 v[96:99], v23, s[16:19], s56 offen sc1
    buffer_store_dwordx4 v[104:107], v23, s[16:19], s57 offen sc1
    buffer_store_dwordx4 v[112:115], v24, s[16:19], s56 offen sc1
    buffer_store_dwordx4 v[120:123], v24, s[16:19], s57 offen sc1
    buffer_store_dwordx4 v[128:131], v25, s[16:19], s56 offen sc1
    buffer_store_dwordx4 v[136:139], v25, s[16:19], s57 offen sc1
    buffer_store_dwordx4 v[144:147], v26, s[16:19], s56 offen sc1
    buffer_store_dwordx4 v[152:155], v26, s[16:19], s57 offen sc1
    buffer_store_dwordx4 v[160:163], v27, s[16:19], s56 offen sc1
    s_mov_b32 s59, 3
    s_waitcnt vmcnt(0)
    s_mov_b64 exec, 1
    buffer_store_dword v11, v5, s[16:19], s62 offen sc1
    s_mov_b64 exec, -1
    s_setpc_b64 s[0:1]
L_slots:
    s_xor_b32 s24, s26, s38
    s_mul_i32 s24, s24, 884736
    s_mov_b32 m0, s27
    s_add_u32 s24, s24, s25
    buffer_load_dwordx4 v2, s[16:19], s24 offen offset:0 sc1 lds
    buffer_load_dwordx4 v2, s[16:19], s24 offen offset:1024 sc1 lds
    buffer_load_dwordx4 v2, s[16:19], s24 offen offset:2048 sc1 lds
    buffer_load_dwordx4 v2, s[16:19], s24 offen offset:3072 sc1 lds
    s_add_u32 m0, s27, 4096
    s_add_u32 s24, s24, 4096
    s_cmp_lt_u32 s26, 4
    s_cbranch_scc1 L_kq85
    s_waitcnt vmcnt(16)
L_kq85:
    buffer_load_dwordx4 v2, s[16:19], s24 offen offset:0 sc1 lds
    buffer_load_dwordx4 v2, s[16:19], s24 offen offset:1024 sc1 lds
    buffer_load_dwordx4 v2, s[16:19], s24 offen offset:2048 sc1 lds
    buffer_load_dwordx4 v2, s[16:19], s24 offen offset:3072 sc1 lds
    s_add_u32 m0, s27, 8192
    s_add_u32 s24, s24, 4096
    s_cmp_lt_u32 s26, 4
    s_cbranch_scc1 L_kq86
    s_waitcnt vmcnt(16)
L_kq86:
    buffer_load_dwordx4 v2, s[16:19], s24 offen offset:0 sc1 lds
    buffer_load_dwordx4 v2, s[16:19], s24 offen offset:1024 sc1 lds
    buffer_load_dwordx4 v2, s[16:19], s24 offen offset:2048 sc1 lds
    buffer_load_dwordx4 v2, s[16:19], s24 offen offset:3072 sc1 lds
    s_add_u32 m0, s27, 12288
    s_add_u32 s24, s24, 4096
    s_cmp_lt_u32 s26, 4
    s_cbranch_scc1 L_kq87
    s_waitcnt vmcnt(16)
L_kq87:
    buffer_load_dwordx4 v2, s[16:19], s24 offen offset:0 sc1 lds
    buffer_load_dwordx4 v2, s[16:19], s24 offen offset:1024 sc1 lds
    buffer_load_dwordx4 v2, s[16:19], s24 offen offset:2048 sc1 lds
    buffer_load_dwordx4 v2, s[16:19], s24 offen offset:3072 sc1 lds
    s_add_u32 m0, s27, 16384
    s_add_u32 s24, s24, 4096
    s_cmp_lt_u32 s26, 4
    s_cbranch_scc1 L_kq88
    s_waitcnt vmcnt(16)
L_kq88:
    buffer_load_dwordx4 v2, s[16:19], s24 offen offset:0 sc1 lds
    buffer_load_dwordx4 v2, s[16:19], s24 offen offset:1024 sc1 lds
    s_cmp_lt_u32 s26, 4
    s_cbranch_scc1 L_kq89
    s_waitcnt vmcnt(16)
L_kq89:
    s_add_u32 s27, s27, 18432
    s_add_u32 s26, s26, 1
    s_sub_u32 s29, s29, 1
    s_cmp_lg_u32 s29, 0
    s_waitcnt vmcnt(45)
    s_cbranch_scc1 L_slots
    s_setpc_b64 s[0:1]
L_helper:
    s_sub_u32 s13, s12, 1
    s_and_b32 s14, s12, 1
    v_lshrrev_b32 v3, 2, v1
    v_mul_u32_u24 v3, 9216, v3
    v_and_b32 v4, 3, v1
    v_lshrrev_b32 v12, 5, v1
    v_lshlrev_b32 v13, 1, v12
    v_xor_b32 v13, v13, v4
    v_lshl_add_u32 v7, v13, 4, v3
    v_lshlrev_b32 v4, 3, v4
    v_bfe_u32 v28, v1, 2, 2
    v_lshrrev_b32 v29, 4, v1
    s_mul_i32 s31, s13, 12288
    s_add_u32 s31, s31, 9216
    v_lshl_add_u32 v3, v29, 3, v28
    v_lshl_or_b32 v13, v3, 6, v4
    v_and_b32 v30, 16, v1
    v_lshl_or_b32 v13, v30, 1, v13
    v_add_u32 v22, s31, v13
    v_xor_b32 v9, 32, v22
    v_lshl_or_b32 v3, v3, 7, v4
    v_bfe_u32 v13, v1, 3, 2
    v_lshl_or_b32 v3, v13, 5, v3
    v_add_u32 v14, s31, v3
    v_lshrrev_b32 v3, 3, v1
    v_mul_u32_u24 v13, 1152, v3
    v_and_b32 v3, 2, v3
    v_and_b32 v4, 7, v1
    v_xor_b32 v4, v4, v3
    v_lshl_add_u32 v15, v4, 4, v13
    v_lshl_add_u32 v16, v1, 2, v10
    s_lshl_b32 s25, s12, 7
    s_add_u32 s25, s25, 158976
    v_and_b32 v3, 15, v1
    v_lshl_or_b32 v4, v12, 4, v3
    v_and_b32 v28, 16, v1
    v_lshl_add_u32 v4, v28, 1, v4
    v_lshl_add_u32 v17, v4, 1, s25
    v_and_b32 v4, 4, v1
    v_add_u32 v4, v4, v29
    v_lshl_add_u32 v18, v4, 4, s25
    v_mul_u32_u24 v4, 2304, v29
    v_lshl_add_u32 v19, v3, 2, v4
    s_mul_i32 s25, s13, 384
    v_lshl_add_u32 v8, v29, 4, s25
    v_and_b32 v3, 3, v1
    v_lshl_add_u32 v8, v3, 24, v8
    v_lshl_add_u32 v18, v3, 13, v18
    v_bfe_i32 v20, v1, 2, 1
    s_lshl_b32 s25, s13, 9
    v_add_u32 v21, s25, v16
    v_xor_b32 v164, 64, v15
    v_xor_b32 v165, 32, v14
    v_xor_b32 v166, 64, v14
    v_xor_b32 v167, 0x60, v14
    v_mov_b64 v[56:57], -1
    v_mov_b64 v[58:59], -1
    v_lshrrev_b32 v3, 3, v1
    s_cmp_eq_u32 s13, 2
    s_cselect_b32 s24, 12, 7
    v_lshlrev_b32 v3, s24, v3
    v_and_b32 v4, 0x70, v2
    v_or_b32 v60, v3, v4
    v_mul_u32_u24 v3, 57, v1
    v_lshrrev_b32 v3, 9, v3
    v_mul_u32_u24 v3, 63, v3
    v_add_lshl_u32 v30, v3, v1, 7
    s_sub_u32 s28, s5, 8
    s_min_u32 s28, s28, 14
    s_mul_i32 s28, s28, 3
    s_add_u32 s28, s28, s13
    s_cmp_eq_u32 s59, 3
    s_cbranch_scc1 L_qok90
    s_movk_i32 s30, 16384
L_poll91:
    ds_read_b32 v4, v10 offset:12
    s_waitcnt lgkmcnt(0)
    v_cmp_eq_u32 vcc, 0, v4
    s_cbranch_vccz L_ok92
    s_sleep 4
    s_sub_u32 s30, s30, 1
    s_cmp_lg_u32 s30, 0
    s_cbranch_scc1 L_poll91
L_ok92:
    v_cmp_eq_u32 vcc, 1, v4
    s_cbranch_vccnz L_qok90
    s_call_b64 s[0:1], L_publish
L_qok90:
    s_movk_i32 s30, 16384
L_poll94:
    ds_read_b64 v[12:13], v10 offset:24
    s_waitcnt lgkmcnt(0)
    v_min_u32 v13, 1, v13
    v_add_u32 v12, v12, v13
    v_cmp_ne_u32 vcc, 9, v12
    s_cbranch_vccz L_ok95
    s_sleep 2
    s_sub_u32 s30, s30, 1
    s_cmp_lg_u32 s30, 0
    s_cbranch_scc1 L_poll94
L_ok95:
    s_mul_i32 s24, s13, 6144
    s_add_u32 s25, s24, 9216
    v_add_u32 v4, s25, v2
    s_setprio 0
    ds_read_b128 v[32:35], v4 offset:0
    ds_read_b128 v[36:39], v4 offset:1024
    ds_read_b128 v[40:43], v4 offset:2048
    ds_read_b128 v[44:47], v4 offset:3072
    ds_read_b128 v[48:51], v4 offset:4096
    ds_read_b128 v[52:55], v4 offset:5120
    s_mul_i32 s25, s38, 884736
    s_add_u32 s24, s24, s25
    s_mul_i32 s25, s39, 27648
    s_add_u32 s24, s24, s25
    s_add_u32 s25, s24, 4096
    s_waitcnt lgkmcnt(0)
    buffer_store_dwordx4 v[32:35], v2, s[16:19], s24 offen offset:0 sc1
    buffer_store_dwordx4 v[36:39], v2, s[16:19], s24 offen offset:1024 sc1
    buffer_store_dwordx4 v[40:43], v2, s[16:19], s24 offen offset:2048 sc1
    buffer_store_dwordx4 v[44:47], v2, s[16:19], s24 offen offset:3072 sc1
    buffer_store_dwordx4 v[48:51], v2, s[16:19], s25 offen offset:0 sc1
    buffer_store_dwordx4 v[52:55], v2, s[16:19], s25 offen offset:1024 sc1
    s_lshl_b32 s24, s38, 8
    s_add_u32 s24, s24, s39
    s_lshl_b32 s25, s24, 10
    s_mul_i32 s26, s13, 98304
    s_add_u32 s25, s25, s26
    s_add_u32 s25, s25, 14680064
    s_add_u32 s26, s25, 32768
    s_add_u32 s27, s25, 65536
    s_lshl_b32 s24, s24, 7
    s_add_u32 s24, s24, 16777216
    s_cmp_eq_u32 s13, 2
    s_cselect_b32 s27, s24, s27
    buffer_store_dwordx4 v[56:59], v2, s[16:19], s25 offen sc1
    buffer_store_dwordx4 v[56:59], v2, s[16:19], s26 offen sc1
    buffer_store_dwordx4 v[56:59], v60, s[16:19], s27 offen sc1
    s_setprio 3
    s_waitcnt vmcnt(0)
    s_mov_b64 exec, 1
    buffer_store_dword v11, v5, s[16:19], s62 offen offset:32 sc1
    ds_add_u32 v10, v11 offset:36
    s_mov_b64 exec, -1
    s_cmp_ge_u32 s28, 42
    s_cbranch_scc1 L_nompf
    s_mov_b32 s54, 5308416
    s_movk_i32 s30, 16384
L_poll97:
    ds_read_b32 v4, v10 offset:28
    s_waitcnt lgkmcnt(0)
    v_cmp_gt_u32 vcc, 2, v4
    s_cbranch_vccz L_ok98
    s_sleep 4
    s_sub_u32 s30, s30, 1
    s_cmp_lg_u32 s30, 0
    s_cbranch_scc1 L_poll97
L_ok98:
    v_lshlrev_b32 v4, 7, v1
    s_mul_i32 s25, s28, 129024
    s_mul_i32 s27, s4, 1152
    s_add_u32 s25, s25, s27
    s_add_u32 s27, s25, 64512
    s_mov_b64 s[52:53], s[42:43]
    buffer_load_dword v31, v30, s[52:55], s25 offen
    buffer_load_dword v31, v30, s[52:55], s27 offen
    s_waitcnt vmcnt(0)
    s_mul_i32 s25, s28, 129024
    s_mul_i32 s27, s4, 1152
    s_add_u32 s25, s25, s27
    s_add_u32 s27, s25, 64512
    s_mov_b64 s[52:53], s[44:45]
    buffer_load_dword v31, v30, s[52:55], s25 offen
    buffer_load_dword v31, v30, s[52:55], s27 offen
    s_waitcnt vmcnt(0)
    s_mul_i32 s25, s28, 15872
    s_mul_i32 s27, s4, 663552
    s_add_u32 s25, s25, s27
    s_add_u32 s27, s25, 7936
    s_mov_b64 s[52:53], s[46:47]
    buffer_load_dword v31, v4, s[52:55], s25 offen
    buffer_load_dword v31, v4, s[52:55], s27 offen
    s_setprio 3
L_nompf:
    s_lshl2_add_u32 s24, s5, s12
    s_cmp_eq_u32 s24, 103
    s_cbranch_scc1 L_select
L_selected:
    s_add_u32 s24, s5, 10
    s_and_b32 s24, s24, 31
    s_mul_i32 s29, s4, 18
    s_add_u32 s29, s29, s24
    s_cmp_lt_u32 s24, 18
    s_cselect_b32 s54, 5308416, 0
    s_mul_i32 s26, s13, 1769472
    s_lshl_b32 s24, s29, 6
    s_add_u32 s26, s26, s24
    s_lshl_b32 s24, s4, 7
    s_add_u32 s24, s24, 19443712
    s_movk_i32 s30, 16384
L_poll100:
    buffer_load_dwordx2 v[12:13], v5, s[16:19], s24 offen sc1
    s_waitcnt vmcnt(0)
    v_min_u32 v4, v12, v13
    v_cmp_eq_u32 vcc, 0, v4
    s_cbranch_vccz L_ok101
    s_sleep 4
    s_sub_u32 s30, s30, 1
    s_cmp_lg_u32 s30, 0
    s_cbranch_scc1 L_poll100
L_ok101:
    s_cmp_lg_u32 s12, 1
    s_cbranch_scc1 L_nog
    ds_write_b64 v10, v[12:13] offset:16
    s_lshl_b32 s24, s15, 2
    s_add_u32 s24, s24, 19340288
    buffer_load_dword v24, v16, s[16:19], s24 offen sc1
    s_waitcnt vmcnt(0)
    ds_write_b32 v16, v24 offset:6144
L_nog:
    s_movk_i32 s30, 16384
L_poll103:
    ds_read_b32 v4, v10 offset:28
    s_waitcnt lgkmcnt(0)
    v_cmp_gt_u32 vcc, 3, v4
    s_cbranch_vccz L_ok104
    s_sleep 8
    s_sub_u32 s30, s30, 1
    s_cmp_lg_u32 s30, 0
    s_cbranch_scc1 L_poll103
L_ok104:
L_sel2:
    v_readfirstlane_b32 s56, v12
    v_readfirstlane_b32 s57, v13
    s_mov_b32 s60, s29
    s_and_b32 s58, s56, 0x7ff
    s_sub_u32 s58, 2047, s58
    s_and_b32 s59, s57, 0x7ff
    s_sub_u32 s59, 2047, s59
    s_cmp_eq_u32 s54, 0
    s_cbranch_scc1 L_moedone
    s_mul_i32 s25, s58, 1152
    s_mul_i32 s24, s59, 1152
    s_sub_u32 s24, s24, s25
    v_and_b32 v20, s24, v20
    v_add3_u32 v8, v8, v20, s25
    buffer_load_dwordx4 v[124:127], v8, s[8:11], 0 offen offset:0
    buffer_load_dwordx4 v[128:131], v8, s[8:11], 0 offen offset:64
    buffer_load_dwordx4 v[132:135], v8, s[8:11], 0 offen offset:128
    buffer_load_dwordx4 v[136:139], v8, s[8:11], 0 offen offset:192
    buffer_load_dwordx4 v[140:143], v8, s[8:11], 0 offen offset:256
    buffer_load_dwordx4 v[144:147], v8, s[8:11], 0 offen offset:320
    s_setprio 0
    s_mov_b32 s52, s42
    s_mov_b32 s53, s43
    s_add_u32 m0, s31, 0
    s_add_u32 s25, s26, 0
    buffer_load_dwordx4 v7, s[52:55], s25 offen lds
    s_add_u32 m0, s31, 1024
    s_add_u32 s25, s26, 147456
    buffer_load_dwordx4 v7, s[52:55], s25 offen lds
    s_add_u32 m0, s31, 2048
    s_add_u32 s25, s26, 294912
    buffer_load_dwordx4 v7, s[52:55], s25 offen lds
    s_add_u32 m0, s31, 3072
    s_add_u32 s25, s26, 442368
    buffer_load_dwordx4 v7, s[52:55], s25 offen lds
    s_add_u32 m0, s31, 4096
    s_add_u32 s25, s26, 589824
    buffer_load_dwordx4 v7, s[52:55], s25 offen lds
    s_add_u32 m0, s31, 5120
    s_add_u32 s25, s26, 737280
    buffer_load_dwordx4 v7, s[52:55], s25 offen lds
    s_add_u32 m0, s31, 6144
    s_add_u32 s25, s26, 884736
    buffer_load_dwordx4 v7, s[52:55], s25 offen lds
    s_add_u32 m0, s31, 7168
    s_add_u32 s25, s26, 1032192
    buffer_load_dwordx4 v7, s[52:55], s25 offen lds
    s_add_u32 m0, s31, 8192
    s_add_u32 s25, s26, 1179648
    buffer_load_dwordx4 v7, s[52:55], s25 offen lds
    s_add_u32 m0, s31, 9216
    s_add_u32 s25, s26, 1327104
    buffer_load_dwordx4 v7, s[52:55], s25 offen lds
    s_add_u32 m0, s31, 10240
    s_add_u32 s25, s26, 1474560
    buffer_load_dwordx4 v7, s[52:55], s25 offen lds
    s_add_u32 m0, s31, 11264
    s_add_u32 s25, s26, 1622016
    buffer_load_dwordx4 v7, s[52:55], s25 offen lds
    s_waitcnt vmcnt(0)
    ds_read_b64_tr_b16 v[28:29], v22 offset:0
    ds_read_b64_tr_b16 v[30:31], v22 offset:256
    ds_read_b64_tr_b16 v[32:33], v9 offset:0
    ds_read_b64_tr_b16 v[34:35], v9 offset:256
    s_waitcnt lgkmcnt(0)
    ds_read_b64_tr_b16 v[36:37], v22 offset:2048
    ds_read_b64_tr_b16 v[38:39], v22 offset:2304
    ds_read_b64_tr_b16 v[40:41], v9 offset:2048
    ds_read_b64_tr_b16 v[42:43], v9 offset:2304
    s_waitcnt lgkmcnt(0)
    ds_read_b64_tr_b16 v[44:45], v22 offset:4096
    ds_read_b64_tr_b16 v[46:47], v22 offset:4352
    ds_read_b64_tr_b16 v[48:49], v9 offset:4096
    ds_read_b64_tr_b16 v[50:51], v9 offset:4352
    s_waitcnt lgkmcnt(0)
    ds_read_b64_tr_b16 v[52:53], v22 offset:6144
    ds_read_b64_tr_b16 v[54:55], v22 offset:6400
    ds_read_b64_tr_b16 v[56:57], v9 offset:6144
    ds_read_b64_tr_b16 v[58:59], v9 offset:6400
    s_waitcnt lgkmcnt(0)
    ds_read_b64_tr_b16 v[60:61], v22 offset:8192
    ds_read_b64_tr_b16 v[62:63], v22 offset:8448
    ds_read_b64_tr_b16 v[64:65], v9 offset:8192
    ds_read_b64_tr_b16 v[66:67], v9 offset:8448
    s_waitcnt lgkmcnt(0)
    ds_read_b64_tr_b16 v[68:69], v22 offset:10240
    ds_read_b64_tr_b16 v[70:71], v22 offset:10496
    ds_read_b64_tr_b16 v[72:73], v9 offset:10240
    ds_read_b64_tr_b16 v[74:75], v9 offset:10496
    s_waitcnt lgkmcnt(0)
    s_waitcnt lgkmcnt(0)
    s_mov_b32 s52, s44
    s_mov_b32 s53, s45
    s_add_u32 m0, s31, 0
    s_add_u32 s25, s26, 0
    buffer_load_dwordx4 v7, s[52:55], s25 offen lds
    s_add_u32 m0, s31, 1024
    s_add_u32 s25, s26, 147456
    buffer_load_dwordx4 v7, s[52:55], s25 offen lds
    s_add_u32 m0, s31, 2048
    s_add_u32 s25, s26, 294912
    buffer_load_dwordx4 v7, s[52:55], s25 offen lds
    s_add_u32 m0, s31, 3072
    s_add_u32 s25, s26, 442368
    buffer_load_dwordx4 v7, s[52:55], s25 offen lds
    s_add_u32 m0, s31, 4096
    s_add_u32 s25, s26, 589824
    buffer_load_dwordx4 v7, s[52:55], s25 offen lds
    s_add_u32 m0, s31, 5120
    s_add_u32 s25, s26, 737280
    buffer_load_dwordx4 v7, s[52:55], s25 offen lds
    s_add_u32 m0, s31, 6144
    s_add_u32 s25, s26, 884736
    buffer_load_dwordx4 v7, s[52:55], s25 offen lds
    s_add_u32 m0, s31, 7168
    s_add_u32 s25, s26, 1032192
    buffer_load_dwordx4 v7, s[52:55], s25 offen lds
    s_add_u32 m0, s31, 8192
    s_add_u32 s25, s26, 1179648
    buffer_load_dwordx4 v7, s[52:55], s25 offen lds
    s_add_u32 m0, s31, 9216
    s_add_u32 s25, s26, 1327104
    buffer_load_dwordx4 v7, s[52:55], s25 offen lds
    s_add_u32 m0, s31, 10240
    s_add_u32 s25, s26, 1474560
    buffer_load_dwordx4 v7, s[52:55], s25 offen lds
    s_add_u32 m0, s31, 11264
    s_add_u32 s25, s26, 1622016
    buffer_load_dwordx4 v7, s[52:55], s25 offen lds
    s_setprio 2
    v_mfma_f32_16x16x32_bf16 v[148:151], v[124:127], v[28:31], 0
    v_mfma_f32_16x16x32_bf16 v[152:155], v[124:127], v[32:35], 0
    v_mfma_f32_16x16x32_bf16 v[148:151], v[128:131], v[36:39], v[148:151]
    v_mfma_f32_16x16x32_bf16 v[152:155], v[128:131], v[40:43], v[152:155]
    v_mfma_f32_16x16x32_bf16 v[148:151], v[132:135], v[44:47], v[148:151]
    v_mfma_f32_16x16x32_bf16 v[152:155], v[132:135], v[48:51], v[152:155]
    v_mfma_f32_16x16x32_bf16 v[148:151], v[136:139], v[52:55], v[148:151]
    v_mfma_f32_16x16x32_bf16 v[152:155], v[136:139], v[56:59], v[152:155]
    v_mfma_f32_16x16x32_bf16 v[148:151], v[140:143], v[60:63], v[148:151]
    v_mfma_f32_16x16x32_bf16 v[152:155], v[140:143], v[64:67], v[152:155]
    v_mfma_f32_16x16x32_bf16 v[148:151], v[144:147], v[68:71], v[148:151]
    v_mfma_f32_16x16x32_bf16 v[152:155], v[144:147], v[72:75], v[152:155]
    s_setprio 0
    s_waitcnt vmcnt(0)
    ds_read_b64_tr_b16 v[76:77], v22 offset:0
    ds_read_b64_tr_b16 v[78:79], v22 offset:256
    ds_read_b64_tr_b16 v[80:81], v9 offset:0
    ds_read_b64_tr_b16 v[82:83], v9 offset:256
    s_waitcnt lgkmcnt(0)
    ds_read_b64_tr_b16 v[84:85], v22 offset:2048
    ds_read_b64_tr_b16 v[86:87], v22 offset:2304
    ds_read_b64_tr_b16 v[88:89], v9 offset:2048
    ds_read_b64_tr_b16 v[90:91], v9 offset:2304
    s_waitcnt lgkmcnt(0)
    ds_read_b64_tr_b16 v[92:93], v22 offset:4096
    ds_read_b64_tr_b16 v[94:95], v22 offset:4352
    ds_read_b64_tr_b16 v[96:97], v9 offset:4096
    ds_read_b64_tr_b16 v[98:99], v9 offset:4352
    s_waitcnt lgkmcnt(0)
    ds_read_b64_tr_b16 v[100:101], v22 offset:6144
    ds_read_b64_tr_b16 v[102:103], v22 offset:6400
    ds_read_b64_tr_b16 v[104:105], v9 offset:6144
    ds_read_b64_tr_b16 v[106:107], v9 offset:6400
    s_waitcnt lgkmcnt(0)
    ds_read_b64_tr_b16 v[108:109], v22 offset:8192
    ds_read_b64_tr_b16 v[110:111], v22 offset:8448
    ds_read_b64_tr_b16 v[112:113], v9 offset:8192
    ds_read_b64_tr_b16 v[114:115], v9 offset:8448
    s_waitcnt lgkmcnt(0)
    ds_read_b64_tr_b16 v[116:117], v22 offset:10240
    ds_read_b64_tr_b16 v[118:119], v22 offset:10496
    ds_read_b64_tr_b16 v[120:121], v9 offset:10240
    ds_read_b64_tr_b16 v[122:123], v9 offset:10496
    s_waitcnt lgkmcnt(0)
    s_waitcnt lgkmcnt(0)
    s_mul_i32 s25, s60, 36864
    s_mul_i32 s26, s13, 384
    s_add_u32 s26, s25, s26
    s_mov_b32 s52, s46
    s_mov_b32 s53, s47
    s_add_u32 m0, s31, 0
    s_add_u32 s25, s26, 0
    buffer_load_dwordx4 v15, s[52:55], s25 offen lds
    s_add_u32 m0, s31, 1024
    s_add_u32 s25, s26, 9216
    buffer_load_dwordx4 v164, s[52:55], s25 offen lds
    s_add_u32 m0, s31, 2048
    s_add_u32 s25, s26, 18432
    buffer_load_dwordx4 v15, s[52:55], s25 offen lds
    s_add_u32 m0, s31, 3072
    s_add_u32 s25, s26, 27648
    buffer_load_dwordx4 v164, s[52:55], s25 offen lds
    s_add_u32 m0, s31, 4096
    s_add_u32 s25, s26, 128
    buffer_load_dwordx4 v15, s[52:55], s25 offen lds
    s_add_u32 m0, s31, 5120
    s_add_u32 s25, s26, 9344
    buffer_load_dwordx4 v164, s[52:55], s25 offen lds
    s_add_u32 m0, s31, 6144
    s_add_u32 s25, s26, 18560
    buffer_load_dwordx4 v15, s[52:55], s25 offen lds
    s_add_u32 m0, s31, 7168
    s_add_u32 s25, s26, 27776
    buffer_load_dwordx4 v164, s[52:55], s25 offen lds
    s_add_u32 m0, s31, 8192
    s_add_u32 s25, s26, 256
    buffer_load_dwordx4 v15, s[52:55], s25 offen lds
    s_add_u32 m0, s31, 9216
    s_add_u32 s25, s26, 9472
    buffer_load_dwordx4 v164, s[52:55], s25 offen lds
    s_add_u32 m0, s31, 10240
    s_add_u32 s25, s26, 18688
    buffer_load_dwordx4 v15, s[52:55], s25 offen lds
    s_add_u32 m0, s31, 11264
    s_add_u32 s25, s26, 27904
    buffer_load_dwordx4 v164, s[52:55], s25 offen lds
    s_setprio 2
    v_mfma_f32_16x16x32_bf16 v[156:159], v[124:127], v[76:79], 0
    v_mfma_f32_16x16x32_bf16 v[160:163], v[124:127], v[80:83], 0
    v_mfma_f32_16x16x32_bf16 v[156:159], v[128:131], v[84:87], v[156:159]
    v_mfma_f32_16x16x32_bf16 v[160:163], v[128:131], v[88:91], v[160:163]
    v_mfma_f32_16x16x32_bf16 v[156:159], v[132:135], v[92:95], v[156:159]
    v_mfma_f32_16x16x32_bf16 v[160:163], v[132:135], v[96:99], v[160:163]
    v_mfma_f32_16x16x32_bf16 v[156:159], v[136:139], v[100:103], v[156:159]
    v_mfma_f32_16x16x32_bf16 v[160:163], v[136:139], v[104:107], v[160:163]
    v_mfma_f32_16x16x32_bf16 v[156:159], v[140:143], v[108:111], v[156:159]
    v_mfma_f32_16x16x32_bf16 v[160:163], v[140:143], v[112:115], v[160:163]
    v_mfma_f32_16x16x32_bf16 v[156:159], v[144:147], v[116:119], v[156:159]
    v_mfma_f32_16x16x32_bf16 v[160:163], v[144:147], v[120:123], v[160:163]
    s_setprio 0
    s_mov_b32 exec_hi, 0
    ds_write_b32 v21, v148 offset:256
    s_not_b64 exec, exec
    ds_write_b32 v21, v152 offset:256
    s_nop 3
    ds_write_b32 v21, v160 offset:512
    s_not_b64 exec, exec
    ds_write_b32 v21, v156 offset:512
    s_mov_b64 exec, 1
    ds_add_u32 v10, v11 offset:0
    s_mov_b64 exec, -1
    s_waitcnt vmcnt(0)
    ds_read_b64_tr_b16 v[28:29], v14 offset:0
    ds_read_b64_tr_b16 v[30:31], v14 offset:512
    ds_read_b64_tr_b16 v[32:33], v165 offset:0
    ds_read_b64_tr_b16 v[34:35], v165 offset:512
    s_waitcnt lgkmcnt(0)
    ds_read_b64_tr_b16 v[36:37], v166 offset:0
    ds_read_b64_tr_b16 v[38:39], v166 offset:512
    ds_read_b64_tr_b16 v[40:41], v167 offset:0
    ds_read_b64_tr_b16 v[42:43], v167 offset:512
    s_waitcnt lgkmcnt(0)
    ds_read_b64_tr_b16 v[44:45], v14 offset:4096
    ds_read_b64_tr_b16 v[46:47], v14 offset:4608
    ds_read_b64_tr_b16 v[48:49], v165 offset:4096
    ds_read_b64_tr_b16 v[50:51], v165 offset:4608
    s_waitcnt lgkmcnt(0)
    ds_read_b64_tr_b16 v[52:53], v166 offset:4096
    ds_read_b64_tr_b16 v[54:55], v166 offset:4608
    ds_read_b64_tr_b16 v[56:57], v167 offset:4096
    ds_read_b64_tr_b16 v[58:59], v167 offset:4608
    s_waitcnt lgkmcnt(0)
    ds_read_b64_tr_b16 v[60:61], v14 offset:8192
    ds_read_b64_tr_b16 v[62:63], v14 offset:8704
    ds_read_b64_tr_b16 v[64:65], v165 offset:8192
    ds_read_b64_tr_b16 v[66:67], v165 offset:8704
    s_waitcnt lgkmcnt(0)
    ds_read_b64_tr_b16 v[68:69], v166 offset:8192
    ds_read_b64_tr_b16 v[70:71], v166 offset:8704
    ds_read_b64_tr_b16 v[72:73], v167 offset:8192
    ds_read_b64_tr_b16 v[74:75], v167 offset:8704
    s_waitcnt lgkmcnt(0)
    s_waitcnt lgkmcnt(0)
    s_mov_b64 exec, 1
    ds_add_u32 v10, v11 offset:36
    s_mov_b64 exec, -1
    s_setprio 3
    s_movk_i32 s30, 16384
L_poll106:
    ds_read_b32 v4, v10 offset:0
    s_waitcnt lgkmcnt(0)
    v_cmp_ne_u32 vcc, 3, v4
    s_cbranch_vccz L_ok107
    s_sleep 4
    s_sub_u32 s30, s30, 1
    s_cmp_lg_u32 s30, 0
    s_cbranch_scc1 L_poll106
L_ok107:
    ds_read_b32 v124, v16 offset:256
    ds_read_b32 v125, v16 offset:512
    ds_read_b32 v126, v16 offset:768
    ds_read_b32 v127, v16 offset:1024
    ds_read_b32 v128, v16 offset:1280
    ds_read_b32 v129, v16 offset:1536
    s_waitcnt lgkmcnt(0)
    v_pk_add_f32 v[124:125], v[124:125], v[126:127]
    v_pk_add_f32 v[124:125], v[124:125], v[128:129]
    v_cvt_pk_bf16_f32 v125, v124, v125
    v_lshlrev_b32 v124, 16, v125
    v_mul_f32 v126, 0xbfb8aa3b, v124
    v_exp_f32 v126, v126
    v_and_b32 v125, 0xffff0000, v125
    v_add_f32 v126, 1.0, v126
    v_rcp_f32 v126, v126
    s_and_b32 s25, s60, 7
    v_mul_f32 v124, v124, v126
    v_cvt_pk_bf16_f32 v124, v124, v124
    v_and_b32 v124, 0xffff0000, v124
    v_mul_f32 v124, v124, v125
    v_cvt_pk_bf16_f32 v124, v124, v124
    ds_write_b16 v17, v124
    ds_read_b128 v[128:131], v18
    s_setprio 2
    s_waitcnt lgkmcnt(0)
    v_mfma_f32_16x16x32_bf16 v[76:79], v[128:131], v[28:31], 0
    v_mfma_f32_16x16x32_bf16 v[80:83], v[128:131], v[32:35], 0
    v_mfma_f32_16x16x32_bf16 v[84:87], v[128:131], v[36:39], 0
    v_mfma_f32_16x16x32_bf16 v[88:91], v[128:131], v[40:43], 0
    v_mfma_f32_16x16x32_bf16 v[92:95], v[128:131], v[44:47], 0
    v_mfma_f32_16x16x32_bf16 v[96:99], v[128:131], v[48:51], 0
    v_mfma_f32_16x16x32_bf16 v[100:103], v[128:131], v[52:55], 0
    v_mfma_f32_16x16x32_bf16 v[104:107], v[128:131], v[56:59], 0
    v_mfma_f32_16x16x32_bf16 v[108:111], v[128:131], v[60:63], 0
    v_mfma_f32_16x16x32_bf16 v[112:115], v[128:131], v[64:67], 0
    v_mfma_f32_16x16x32_bf16 v[116:119], v[128:131], v[68:71], 0
    v_mfma_f32_16x16x32_bf16 v[120:123], v[128:131], v[72:75], 0
    s_setprio 3
    s_mul_i32 s25, s25, 4608
    s_mul_i32 s26, s13, 768
    s_add_u32 s25, s25, s26
    s_add_u32 s25, s25, 19447808
    s_mov_b32 exec_hi, 0
    buffer_atomic_add_f32 v76, v19, s[16:19], s25 offen offset:0 sc1
    buffer_atomic_add_f32 v80, v19, s[16:19], s25 offen offset:64 sc1
    buffer_atomic_add_f32 v84, v19, s[16:19], s25 offen offset:128 sc1
    buffer_atomic_add_f32 v88, v19, s[16:19], s25 offen offset:192 sc1
    buffer_atomic_add_f32 v92, v19, s[16:19], s25 offen offset:256 sc1
    buffer_atomic_add_f32 v96, v19, s[16:19], s25 offen offset:320 sc1
    buffer_atomic_add_f32 v100, v19, s[16:19], s25 offen offset:384 sc1
    buffer_atomic_add_f32 v104, v19, s[16:19], s25 offen offset:448 sc1
    buffer_atomic_add_f32 v108, v19, s[16:19], s25 offen offset:512 sc1
    buffer_atomic_add_f32 v112, v19, s[16:19], s25 offen offset:576 sc1
    buffer_atomic_add_f32 v116, v19, s[16:19], s25 offen offset:640 sc1
    buffer_atomic_add_f32 v120, v19, s[16:19], s25 offen offset:704 sc1
    s_mov_b64 exec, 1
    s_setprio 3
    s_waitcnt vmcnt(0)
    ds_add_rtn_u32 v4, v10, v11 offset:4
    s_andn2_b32 s25, s62, 127
    s_waitcnt lgkmcnt(0)
    v_cmp_eq_u32 vcc, 2, v4
    s_cbranch_vccz L_notlast
    buffer_store_dword v11, v5, s[16:19], s25 offen offset:64 sc1
L_notlast:
    s_mov_b64 exec, -1
L_moedone:
    s_cmp_eq_u32 s12, 2
    s_cselect_b32 s26, s58, s59
    s_cselect_b32 s27, s56, s57
    s_andn2_b32 s24, s26, 63
    s_cmp_eq_u32 s15, s24
    s_cselect_b32 s28, 1, 0
    s_cmp_eq_u32 s12, 1
    s_cselect_b32 s28, 0, s28
    s_cmp_eq_u32 s28, 0
    s_cbranch_scc1 L_h_wait
    v_min_u32 v15, 35, v1
    v_lshlrev_b32 v3, 2, v15
    s_lshr_b32 s24, s5, 2
    s_mul_i32 s24, s24, 144
    s_mul_i32 s25, s26, 1152
    s_add_u32 s24, s24, s25
    buffer_load_dword v19, v3, s[8:11], s24 offen
    s_lshl_b32 s24, s26, 2
    s_add_u32 s24, s24, 19496960
    buffer_load_dword v16, v5, s[16:19], s24 offen sc1
    v_lshlrev_b32 v15, 3, v15
    s_mul_i32 s24, s14, 320
    s_add_u32 s24, s24, 159488
    v_add_u32 v14, s24, v15
    v_lshlrev_b32 v3, 7, v1
    s_mov_b32 s29, 19398656
    s_mov_b32 s31, 19421184
    s_and_b32 s27, s27, 0xfffff800
    s_xor_b32 s24, s27, 0x80000000
    s_not_b32 s25, s27
    s_bitcmp1_b32 s27, 31
    s_cselect_b32 s27, s24, s25
    v_mov_b32 v20, s27
    v_cvt_pk_bf16_f32 v20, v20, v20
    v_and_b32 v20, 0xffff0000, v20
    v_mul_f32 v20, 0xbfb8aa3b, v20
    v_exp_f32 v20, v20
    s_nop 0
    v_add_f32 v20, 1.0, v20
    v_rcp_f32 v20, v20
    s_nop 0
    v_cvt_pk_bf16_f32 v20, v20, v20
    v_and_b32 v20, 0xffff0000, v20
    s_waitcnt vmcnt(0)
    v_sub_f32 v16, 1.0, v16
    v_lshlrev_b32 v18, 16, v19
    v_and_b32 v19, 0xffff0000, v19
    v_cvt_pk_bf16_f32 v16, v16, v16
    v_and_b32 v16, 0xffff0000, v16
    s_movk_i32 s30, 16384
L_poll109:
    ds_read_b32 v12, v10 offset:128
    s_waitcnt lgkmcnt(0)
    v_cmp_lt_u32 vcc, 0, v12
    s_cbranch_vccnz L_h_wait
    buffer_load_dword v22, v3, s[16:19], s29 offen offset:64 sc1
    buffer_load_dword v23, v3, s[16:19], s31 offen offset:64 sc1
    buffer_load_dword v24, v3, s[16:19], s31 offen offset:2112 sc1
    s_waitcnt vmcnt(0)
    v_bitop3_b32 v4, v22, v23, v24 bitop3:0x80
    v_cmp_ne_u32 vcc, 1, v4
    s_cbranch_vccz L_ok110
    s_sleep 8
    s_sub_u32 s30, s30, 1
    s_cmp_lg_u32 s30, 0
    s_cbranch_scc1 L_poll109
L_ok110:
    s_call_b64 s[0:1], L_yprep
L_h_wait:
    s_waitcnt vmcnt(0) lgkmcnt(0)
    s_barrier
    ds_read_b32 v4, v10 offset:8
    s_waitcnt lgkmcnt(0)
    v_cmp_lt_u32 vcc, s61, v4
    s_cbranch_vccnz L_h_fb
    s_cmp_eq_u32 s28, 0
    s_cbranch_scc1 L_h_end
    s_movk_i32 s30, 16384
L_poll112:
    buffer_load_dword v22, v3, s[16:19], s29 offen offset:64 sc1
    buffer_load_dword v23, v3, s[16:19], s31 offen offset:64 sc1
    buffer_load_dword v24, v3, s[16:19], s31 offen offset:2112 sc1
    s_waitcnt vmcnt(0)
    v_bitop3_b32 v4, v22, v23, v24 bitop3:0x80
    v_cmp_ne_u32 vcc, 1, v4
    s_cbranch_vccz L_ok113
    s_sleep 2
    s_sub_u32 s30, s30, 1
    s_cmp_lg_u32 s30, 0
    s_cbranch_scc1 L_poll112
L_ok113:
    s_call_b64 s[0:1], L_yprep
    s_waitcnt lgkmcnt(0)
L_h_end:
    s_endpgm
L_h_fb:
    s_barrier
    s_barrier
    s_mov_b32 s61, -1
    s_barrier
    s_branch L_h_wait
L_yprep:
    s_mov_b32 s28, 0
    s_lshr_b32 s24, s5, 2
    s_mul_i32 s24, s24, 288
    s_mul_i32 s25, s14, 2304
    s_add_u32 s24, s24, s25
    s_add_u32 s24, s24, 19447808
    buffer_load_dwordx2 v[32:33], v15, s[16:19], s24 offen sc1
    s_add_u32 s24, s24, 4608
    buffer_load_dwordx2 v[34:35], v15, s[16:19], s24 offen sc1
    s_add_u32 s24, s24, 4608
    buffer_load_dwordx2 v[36:37], v15, s[16:19], s24 offen sc1
    s_add_u32 s24, s24, 4608
    buffer_load_dwordx2 v[38:39], v15, s[16:19], s24 offen sc1
    s_add_u32 s24, s24, 4608
    buffer_load_dwordx2 v[40:41], v15, s[16:19], s24 offen sc1
    s_add_u32 s24, s24, 4608
    buffer_load_dwordx2 v[42:43], v15, s[16:19], s24 offen sc1
    s_add_u32 s24, s24, 4608
    buffer_load_dwordx2 v[44:45], v15, s[16:19], s24 offen sc1
    s_add_u32 s24, s24, 4608
    buffer_load_dwordx2 v[46:47], v15, s[16:19], s24 offen sc1
    s_add_u32 s24, s24, 4608
    s_waitcnt vmcnt(0)
    v_pk_add_f32 v[32:33], v[32:33], v[34:35]
    v_pk_add_f32 v[32:33], v[32:33], v[36:37]
    v_pk_add_f32 v[32:33], v[32:33], v[38:39]
    v_pk_add_f32 v[32:33], v[32:33], v[40:41]
    v_pk_add_f32 v[32:33], v[32:33], v[42:43]
    v_pk_add_f32 v[32:33], v[32:33], v[44:45]
    v_pk_add_f32 v[32:33], v[32:33], v[46:47]
    v_cvt_pk_bf16_f32 v33, v32, v33
    v_lshlrev_b32 v32, 16, v33
    v_and_b32 v33, 0xffff0000, v33
    v_pk_mul_f32 v[32:33], v[32:33], v[20:21] op_sel_hi:[1,0]
    v_cvt_pk_bf16_f32 v33, v32, v33
    v_lshlrev_b32 v32, 16, v33
    v_and_b32 v33, 0xffff0000, v33
    v_pk_add_f32 v[32:33], v[32:33], v[18:19]
    v_cvt_pk_bf16_f32 v33, v32, v33
    v_lshlrev_b32 v32, 16, v33
    v_and_b32 v33, 0xffff0000, v33
    v_pk_mul_f32 v[32:33], v[32:33], v[16:17] op_sel_hi:[1,0]
    v_cvt_pk_bf16_f32 v33, v32, v33
    v_lshlrev_b32 v32, 16, v33
    v_and_b32 v33, 0xffff0000, v33
    ds_write_b64 v14, v[32:33]
    s_setpc_b64 s[0:1]
L_idle:
    v_mov_b32 v5, 0
    v_mov_b32 v6, s7
    s_barrier
    v_and_b32 v3, 7, v1
    v_lshlrev_b32 v3, 5, v3
    s_movk_i32 s30, 16384
L_poll115:
    buffer_load_dword v4, v3, s[20:23], 0 offen sc1
    s_waitcnt vmcnt(0)
    v_cmp_eq_u32 vcc, 0, v4
    s_cbranch_vccz L_ok116
    s_sleep 32
    s_sub_u32 s30, s30, 1
    s_cmp_lg_u32 s30, 0
    s_cbranch_scc1 L_poll115
L_ok116:
    s_branch L_svc
L_rg:
    s_cmp_ge_u32 s12, 2
    s_cbranch_scc1 L_idle
    s_sub_u32 s26, s5, 24
    s_lshl3_add_u32 s26, s6, s26
    s_lshl1_add_u32 s27, s26, s12
    s_lshl_b32 s28, s27, 4
    v_lshrrev_b32 v3, 3, v1
    v_add_u32 v4, s28, v3
    v_mul_u32_u24 v5, 1152, v4
    v_and_b32 v6, 7, v1
    v_lshlrev_b32 v6, 4, v6
    v_add_u32 v5, v5, v6
    v_add_u32 v7, 9216, v5
    s_barrier
    global_load_dwordx4 v[16:19], v5, s[32:33] offset:0
    global_load_dwordx4 v[20:23], v5, s[32:33] offset:128
    global_load_dwordx4 v[24:27], v5, s[32:33] offset:256
    global_load_dwordx4 v[28:31], v5, s[32:33] offset:384
    global_load_dwordx4 v[32:35], v5, s[32:33] offset:512
    global_load_dwordx4 v[36:39], v5, s[32:33] offset:640
    global_load_dwordx4 v[40:43], v5, s[32:33] offset:768
    global_load_dwordx4 v[44:47], v5, s[32:33] offset:896
    global_load_dwordx4 v[48:51], v5, s[32:33] offset:1024
    global_load_dwordx4 v[88:91], v6, s[40:41] offset:0
    global_load_dwordx4 v[92:95], v6, s[40:41] offset:128
    global_load_dwordx4 v[96:99], v6, s[40:41] offset:256
    global_load_dwordx4 v[100:103], v6, s[40:41] offset:384
    global_load_dwordx4 v[104:107], v6, s[40:41] offset:512
    global_load_dwordx4 v[108:111], v6, s[40:41] offset:640
    global_load_dwordx4 v[112:115], v6, s[40:41] offset:768
    global_load_dwordx4 v[116:119], v6, s[40:41] offset:896
    global_load_dwordx4 v[120:123], v6, s[40:41] offset:1024
    global_load_dwordx4 v[124:127], v6, s[48:49] offset:0
    global_load_dwordx4 v[128:131], v6, s[48:49] offset:128
    global_load_dwordx4 v[132:135], v6, s[48:49] offset:256
    global_load_dwordx4 v[136:139], v6, s[48:49] offset:384
    global_load_dwordx4 v[140:143], v6, s[48:49] offset:512
    global_load_dwordx4 v[144:147], v6, s[48:49] offset:640
    global_load_dwordx4 v[148:151], v6, s[48:49] offset:768
    global_load_dwordx4 v[152:155], v6, s[48:49] offset:896
    global_load_dwordx4 v[156:159], v6, s[48:49] offset:1024
    global_load_dwordx4 v[52:55], v7, s[32:33] offset:0
    global_load_dwordx4 v[56:59], v7, s[32:33] offset:128
    global_load_dwordx4 v[60:63], v7, s[32:33] offset:256
    global_load_dwordx4 v[64:67], v7, s[32:33] offset:384
    global_load_dwordx4 v[68:71], v7, s[32:33] offset:512
    global_load_dwordx4 v[72:75], v7, s[32:33] offset:640
    global_load_dwordx4 v[76:79], v7, s[32:33] offset:768
    global_load_dwordx4 v[80:83], v7, s[32:33] offset:896
    global_load_dwordx4 v[84:87], v7, s[32:33] offset:1024
    s_waitcnt lgkmcnt(0)
    v_mov_b64 v[8:9], 0
    v_mov_b64 v[10:11], 0
    s_waitcnt vmcnt(0)
    v_dot2c_f32_bf16 v8, v16, v88
    v_dot2c_f32_bf16 v9, v52, v88
    v_dot2c_f32_bf16 v10, v16, v124
    v_dot2c_f32_bf16 v11, v52, v124
    v_dot2c_f32_bf16 v8, v17, v89
    v_dot2c_f32_bf16 v9, v53, v89
    v_dot2c_f32_bf16 v10, v17, v125
    v_dot2c_f32_bf16 v11, v53, v125
    v_dot2c_f32_bf16 v8, v18, v90
    v_dot2c_f32_bf16 v9, v54, v90
    v_dot2c_f32_bf16 v10, v18, v126
    v_dot2c_f32_bf16 v11, v54, v126
    v_dot2c_f32_bf16 v8, v19, v91
    v_dot2c_f32_bf16 v9, v55, v91
    v_dot2c_f32_bf16 v10, v19, v127
    v_dot2c_f32_bf16 v11, v55, v127
    v_dot2c_f32_bf16 v8, v20, v92
    v_dot2c_f32_bf16 v9, v56, v92
    v_dot2c_f32_bf16 v10, v20, v128
    v_dot2c_f32_bf16 v11, v56, v128
    v_dot2c_f32_bf16 v8, v21, v93
    v_dot2c_f32_bf16 v9, v57, v93
    v_dot2c_f32_bf16 v10, v21, v129
    v_dot2c_f32_bf16 v11, v57, v129
    v_dot2c_f32_bf16 v8, v22, v94
    v_dot2c_f32_bf16 v9, v58, v94
    v_dot2c_f32_bf16 v10, v22, v130
    v_dot2c_f32_bf16 v11, v58, v130
    v_dot2c_f32_bf16 v8, v23, v95
    v_dot2c_f32_bf16 v9, v59, v95
    v_dot2c_f32_bf16 v10, v23, v131
    v_dot2c_f32_bf16 v11, v59, v131
    v_dot2c_f32_bf16 v8, v24, v96
    v_dot2c_f32_bf16 v9, v60, v96
    v_dot2c_f32_bf16 v10, v24, v132
    v_dot2c_f32_bf16 v11, v60, v132
    v_dot2c_f32_bf16 v8, v25, v97
    v_dot2c_f32_bf16 v9, v61, v97
    v_dot2c_f32_bf16 v10, v25, v133
    v_dot2c_f32_bf16 v11, v61, v133
    v_dot2c_f32_bf16 v8, v26, v98
    v_dot2c_f32_bf16 v9, v62, v98
    v_dot2c_f32_bf16 v10, v26, v134
    v_dot2c_f32_bf16 v11, v62, v134
    v_dot2c_f32_bf16 v8, v27, v99
    v_dot2c_f32_bf16 v9, v63, v99
    v_dot2c_f32_bf16 v10, v27, v135
    v_dot2c_f32_bf16 v11, v63, v135
    v_dot2c_f32_bf16 v8, v28, v100
    v_dot2c_f32_bf16 v9, v64, v100
    v_dot2c_f32_bf16 v10, v28, v136
    v_dot2c_f32_bf16 v11, v64, v136
    v_dot2c_f32_bf16 v8, v29, v101
    v_dot2c_f32_bf16 v9, v65, v101
    v_dot2c_f32_bf16 v10, v29, v137
    v_dot2c_f32_bf16 v11, v65, v137
    v_dot2c_f32_bf16 v8, v30, v102
    v_dot2c_f32_bf16 v9, v66, v102
    v_dot2c_f32_bf16 v10, v30, v138
    v_dot2c_f32_bf16 v11, v66, v138
    v_dot2c_f32_bf16 v8, v31, v103
    v_dot2c_f32_bf16 v9, v67, v103
    v_dot2c_f32_bf16 v10, v31, v139
    v_dot2c_f32_bf16 v11, v67, v139
    v_dot2c_f32_bf16 v8, v32, v104
    v_dot2c_f32_bf16 v9, v68, v104
    v_dot2c_f32_bf16 v10, v32, v140
    v_dot2c_f32_bf16 v11, v68, v140
    v_dot2c_f32_bf16 v8, v33, v105
    v_dot2c_f32_bf16 v9, v69, v105
    v_dot2c_f32_bf16 v10, v33, v141
    v_dot2c_f32_bf16 v11, v69, v141
    v_dot2c_f32_bf16 v8, v34, v106
    v_dot2c_f32_bf16 v9, v70, v106
    v_dot2c_f32_bf16 v10, v34, v142
    v_dot2c_f32_bf16 v11, v70, v142
    v_dot2c_f32_bf16 v8, v35, v107
    v_dot2c_f32_bf16 v9, v71, v107
    v_dot2c_f32_bf16 v10, v35, v143
    v_dot2c_f32_bf16 v11, v71, v143
    v_dot2c_f32_bf16 v8, v36, v108
    v_dot2c_f32_bf16 v9, v72, v108
    v_dot2c_f32_bf16 v10, v36, v144
    v_dot2c_f32_bf16 v11, v72, v144
    v_dot2c_f32_bf16 v8, v37, v109
    v_dot2c_f32_bf16 v9, v73, v109
    v_dot2c_f32_bf16 v10, v37, v145
    v_dot2c_f32_bf16 v11, v73, v145
    v_dot2c_f32_bf16 v8, v38, v110
    v_dot2c_f32_bf16 v9, v74, v110
    v_dot2c_f32_bf16 v10, v38, v146
    v_dot2c_f32_bf16 v11, v74, v146
    v_dot2c_f32_bf16 v8, v39, v111
    v_dot2c_f32_bf16 v9, v75, v111
    v_dot2c_f32_bf16 v10, v39, v147
    v_dot2c_f32_bf16 v11, v75, v147
    v_dot2c_f32_bf16 v8, v40, v112
    v_dot2c_f32_bf16 v9, v76, v112
    v_dot2c_f32_bf16 v10, v40, v148
    v_dot2c_f32_bf16 v11, v76, v148
    v_dot2c_f32_bf16 v8, v41, v113
    v_dot2c_f32_bf16 v9, v77, v113
    v_dot2c_f32_bf16 v10, v41, v149
    v_dot2c_f32_bf16 v11, v77, v149
    v_dot2c_f32_bf16 v8, v42, v114
    v_dot2c_f32_bf16 v9, v78, v114
    v_dot2c_f32_bf16 v10, v42, v150
    v_dot2c_f32_bf16 v11, v78, v150
    v_dot2c_f32_bf16 v8, v43, v115
    v_dot2c_f32_bf16 v9, v79, v115
    v_dot2c_f32_bf16 v10, v43, v151
    v_dot2c_f32_bf16 v11, v79, v151
    v_dot2c_f32_bf16 v8, v44, v116
    v_dot2c_f32_bf16 v9, v80, v116
    v_dot2c_f32_bf16 v10, v44, v152
    v_dot2c_f32_bf16 v11, v80, v152
    v_dot2c_f32_bf16 v8, v45, v117
    v_dot2c_f32_bf16 v9, v81, v117
    v_dot2c_f32_bf16 v10, v45, v153
    v_dot2c_f32_bf16 v11, v81, v153
    v_dot2c_f32_bf16 v8, v46, v118
    v_dot2c_f32_bf16 v9, v82, v118
    v_dot2c_f32_bf16 v10, v46, v154
    v_dot2c_f32_bf16 v11, v82, v154
    v_dot2c_f32_bf16 v8, v47, v119
    v_dot2c_f32_bf16 v9, v83, v119
    v_dot2c_f32_bf16 v10, v47, v155
    v_dot2c_f32_bf16 v11, v83, v155
    v_dot2c_f32_bf16 v8, v48, v120
    v_dot2c_f32_bf16 v9, v84, v120
    v_dot2c_f32_bf16 v10, v48, v156
    v_dot2c_f32_bf16 v11, v84, v156
    v_dot2c_f32_bf16 v8, v49, v121
    v_dot2c_f32_bf16 v9, v85, v121
    v_dot2c_f32_bf16 v10, v49, v157
    v_dot2c_f32_bf16 v11, v85, v157
    v_dot2c_f32_bf16 v8, v50, v122
    v_dot2c_f32_bf16 v9, v86, v122
    v_dot2c_f32_bf16 v10, v50, v158
    v_dot2c_f32_bf16 v11, v86, v158
    v_dot2c_f32_bf16 v8, v51, v123
    v_dot2c_f32_bf16 v9, v87, v123
    v_dot2c_f32_bf16 v10, v51, v159
    v_dot2c_f32_bf16 v11, v87, v159
    s_nop 2
    v_add_f32_dpp v8, v8, v8 quad_perm:[1,0,3,2] row_mask:0xf bank_mask:0xf
    v_add_f32_dpp v9, v9, v9 quad_perm:[1,0,3,2] row_mask:0xf bank_mask:0xf
    v_add_f32_dpp v10, v10, v10 quad_perm:[1,0,3,2] row_mask:0xf bank_mask:0xf
    v_add_f32_dpp v11, v11, v11 quad_perm:[1,0,3,2] row_mask:0xf bank_mask:0xf
    v_add_f32_dpp v8, v8, v8 quad_perm:[2,3,0,1] row_mask:0xf bank_mask:0xf
    v_add_f32_dpp v9, v9, v9 quad_perm:[2,3,0,1] row_mask:0xf bank_mask:0xf
    v_add_f32_dpp v10, v10, v10 quad_perm:[2,3,0,1] row_mask:0xf bank_mask:0xf
    v_add_f32_dpp v11, v11, v11 quad_perm:[2,3,0,1] row_mask:0xf bank_mask:0xf
    v_add_f32_dpp v8, v8, v8 row_half_mirror row_mask:0xf bank_mask:0xf
    v_add_f32_dpp v9, v9, v9 row_half_mirror row_mask:0xf bank_mask:0xf
    v_add_f32_dpp v10, v10, v10 row_half_mirror row_mask:0xf bank_mask:0xf
    v_add_f32_dpp v11, v11, v11 row_half_mirror row_mask:0xf bank_mask:0xf
    v_and_b32 v12, 1, v1
    v_cmp_eq_u32 vcc, 0, v12
    v_lshlrev_b32 v13, 2, v4
    v_lshl_add_u32 v13, v12, 5, v13
    v_cndmask_b32 v10, v11, v10, vcc
    v_cvt_pk_bf16_f32 v10, v10, v10
    v_and_b32 v10, 0xffff0000, v10
    v_mul_f32 v10, 0xbfb8aa3b, v10
    v_exp_f32 v10, v10
    s_nop 0
    v_add_f32 v10, 1.0, v10
    v_rcp_f32 v10, v10
    s_nop 0
    v_cvt_pk_bf16_f32 v10, v10, v10
    v_and_b32 v10, 0xffff0000, v10
    s_mov_b32 s29, 19496960
    buffer_store_dword v10, v13, s[16:19], s29 offen sc1
    v_ashrrev_i32 v12, 31, v8
    v_or_b32 v12, 0x80000000, v12
    v_xor_b32 v8, v8, v12
    v_and_b32 v8, 0xfffff800, v8
    v_sub_u32 v12, 2047, v4
    v_or_b32 v8, v8, v12
    v_ashrrev_i32 v12, 31, v9
    v_or_b32 v12, 0x80000000, v12
    v_xor_b32 v9, v9, v12
    v_and_b32 v9, 0xfffff800, v9
    v_sub_u32 v12, 2039, v4
    v_or_b32 v9, v9, v12
    v_max_u32 v14, v8, v9
    v_min_u32 v15, v8, v9
    s_nop 1
    v_mov_b32_dpp v8, v14 row_ror:8 row_mask:0xf bank_mask:0xf
    v_mov_b32_dpp v9, v15 row_ror:8 row_mask:0xf bank_mask:0xf
    v_min_u32 v12, v8, v14
    v_max_u32 v14, v8, v14
    v_max3_u32 v15, v12, v9, v15
    v_mov_b32 v8, v14
    v_mov_b32 v9, v15
    s_nop 1
    v_permlane16_swap_b32 v8, v14
    v_permlane16_swap_b32 v9, v15
    s_nop 1
    v_min_u32 v12, v8, v14
    v_max_u32 v14, v8, v14
    v_max3_u32 v15, v12, v9, v15
    v_mov_b32 v8, v14
    v_mov_b32 v9, v15
    s_nop 1
    v_permlane32_swap_b32 v8, v14
    v_permlane32_swap_b32 v9, v15
    s_nop 1
    v_min_u32 v12, v8, v14
    v_max_u32 v14, v8, v14
    v_max3_u32 v15, v12, v9, v15
    v_and_b32 v3, 7, v1
    v_lshlrev_b32 v3, 5, v3
    s_movk_i32 s30, 16384
L_poll118:
    buffer_load_dword v4, v3, s[20:23], 0 offen sc1
    s_waitcnt vmcnt(0)
    v_cmp_eq_u32 vcc, 0, v4
    s_cbranch_vccz L_ok119
    s_sleep 8
    s_sub_u32 s30, s30, 1
    s_cmp_lg_u32 s30, 0
    s_cbranch_scc1 L_poll118
L_ok119:
    s_lshl_b32 s29, s27, 6
    s_add_u32 s29, s29, 19484672
    v_mov_b32 v5, 0
    v_mov_b32 v6, s7
    v_lshlrev_b32 v3, 3, v1
    s_mov_b64 exec, 0xff
    buffer_store_dwordx2 v[14:15], v3, s[16:19], s29 offen sc1
    s_mov_b64 exec, -1
    s_branch L_svc
L_select:
    v_lshlrev_b32 v3, 7, v1
    s_mov_b32 s29, 19484672
    s_movk_i32 s30, 16384
L_poll121:
    buffer_load_dwordx2 v[32:33], v3, s[16:19], s29 offen sc1
    buffer_load_dwordx2 v[34:35], v3, s[16:19], s29 offen offset:64 sc1
    s_waitcnt vmcnt(0)
    v_min_u32 v12, v32, v33
    v_min3_u32 v12, v12, v34, v35
    v_cmp_eq_u32 vcc, 0, v12
    s_cbranch_vccz L_ok122
    s_sleep 8
    s_sub_u32 s30, s30, 1
    s_cmp_lg_u32 s30, 0
    s_cbranch_scc1 L_poll121
L_ok122:
    v_min_u32 v12, v32, v34
    v_max_u32 v32, v32, v34
    v_max3_u32 v33, v12, v33, v35
    v_mov_b32 v34, v32
    s_nop 1
    v_max_u32_dpp v34, v34, v34 quad_perm:[1,0,3,2] row_mask:0xf bank_mask:0xf
    s_nop 1
    v_max_u32_dpp v34, v34, v34 quad_perm:[2,3,0,1] row_mask:0xf bank_mask:0xf
    s_nop 1
    v_max_u32_dpp v34, v34, v34 row_half_mirror row_mask:0xf bank_mask:0xf
    s_nop 1
    v_max_u32_dpp v34, v34, v34 row_mirror row_mask:0xf bank_mask:0xf
    v_mov_b32 v12, v34
    s_nop 1
    v_permlane16_swap_b32 v12, v34
    s_nop 1
    v_max_u32 v34, v12, v34
    v_mov_b32 v12, v34
    s_nop 1
    v_permlane32_swap_b32 v12, v34
    s_nop 1
    v_max_u32 v34, v12, v34
    s_nop 0
    v_readfirstlane_b32 s24, v34
    v_cmp_eq_u32 vcc, v34, v32
    s_nop 1
    v_cndmask_b32 v34, v32, v33, vcc
    s_nop 1
    v_max_u32_dpp v34, v34, v34 quad_perm:[1,0,3,2] row_mask:0xf bank_mask:0xf
    s_nop 1
    v_max_u32_dpp v34, v34, v34 quad_perm:[2,3,0,1] row_mask:0xf bank_mask:0xf
    s_nop 1
    v_max_u32_dpp v34, v34, v34 row_half_mirror row_mask:0xf bank_mask:0xf
    s_nop 1
    v_max_u32_dpp v34, v34, v34 row_mirror row_mask:0xf bank_mask:0xf
    v_mov_b32 v12, v34
    s_nop 1
    v_permlane16_swap_b32 v12, v34
    s_nop 1
    v_max_u32 v34, v12, v34
    v_mov_b32 v12, v34
    s_nop 1
    v_permlane32_swap_b32 v12, v34
    s_nop 1
    v_max_u32 v34, v12, v34
    s_nop 0
    v_readfirstlane_b32 s25, v34
    s_lshl_b32 s29, s4, 7
    s_add_u32 s29, s29, 19443712
    v_mov_b32 v32, s24
    v_mov_b32 v33, s25
    v_lshlrev_b32 v3, 3, v1
    s_mov_b64 exec, 0xff
    buffer_store_dwordx2 v[32:33], v3, s[16:19], s29 offen sc1
    s_mov_b64 exec, -1
    s_branch L_selected
L_codeend:
.section .rodata,"a"
.p2align 6
.amdhsa_kernel gated_mix__mha_block__moe_arch_mod__prompt_kernel
  .amdhsa_next_free_vgpr 168
  .amdhsa_next_free_sgpr 64
  .amdhsa_accum_offset 168
  .amdhsa_group_segment_fixed_size 0
  .amdhsa_kernarg_size 96
  .amdhsa_user_sgpr_count 2
  .amdhsa_user_sgpr_kernarg_segment_ptr 1
  .amdhsa_system_sgpr_workgroup_id_x 1
  .amdhsa_float_denorm_mode_32 3
.end_amdhsa_kernel
```
